```python
import torch

def _softmax(x, axis=-1):
    return torch.softmax(x, dim=axis)
def _gelu(x):
    return torch.nn.functional.gelu(x, approximate="tanh")
def _silu(x):
    return torch.nn.functional.silu(x)
def _sigmoid(x):
    return torch.sigmoid(x)
def _layernorm(x, axis=-1, eps=1e-5):
    m = x.mean(dim=axis, keepdim=True)
    v = x.var(dim=axis, keepdim=True, unbiased=False)
    return (x - m) / torch.sqrt(v + eps)
def _scatter_add(tgt, idx, src, axis=0):
    return tgt.clone().index_add_(axis, idx, src)
def _segment_sum(src, seg, n):
    out = torch.zeros((n,) + src.shape[1:], dtype=src.dtype)
    return out.index_add_(0, seg, src)
def _pad(x, pw):
    flat = tuple(v for pair in reversed(pw) for v in pair)
    return torch.nn.functional.pad(x, flat)

kernel_name = 'parallel_sum__mha_block_cached__glu_gated_geglu__decode'

def setup_inputs():

    _w = (lambda a: (lambda t: t.to(torch.bfloat16) if t.is_floating_point() else t)(torch.as_tensor(a)))
    def _A_setup():
        B, Sq, D = 1, 1, 1024
        H, Sk, Dh = 32, 65536, 128
        return {
            "x": _w((lambda *s: torch.randn(*s, dtype=torch.bfloat16) * 0.05)(B, Sq, D)),
            "k_cache": _w((lambda *s: torch.randn(*s, dtype=torch.bfloat16) * 3.2)(B, H, Sk, Dh)),
            "v_cache": _w((lambda *s: torch.randn(*s, dtype=torch.bfloat16) * 1.6)(B, H, Sk, Dh)),
            "wq": _w((lambda *s: torch.randn(*s, dtype=torch.bfloat16) * 3.2)(D, H * Dh) * (D ** -0.5)),
            "wo": _w((lambda *s: torch.randn(*s, dtype=torch.bfloat16) * 1.6)(H * Dh, D) * ((H * Dh) ** -0.5)),
        }
    _A_in = _A_setup()

    def _B_setup():
        B, S, Dm, Df = 1, 1, 1024, 3584
        return {
            "x": _w((lambda *s: torch.randn(*s, dtype=torch.bfloat16) * 0.05)(B, S, Dm)),
            "w_gate": _w((lambda *s: torch.randn(*s, dtype=torch.bfloat16) * 1.6)(Dm, Df) * (Dm ** -0.5)),
            "w_up": _w((lambda *s: torch.randn(*s, dtype=torch.bfloat16) * 1.6)(Dm, Df) * (Dm ** -0.5)),
            "w_down": _w((lambda *s: torch.randn(*s, dtype=torch.bfloat16) * 1.6)(Df, Dm) * (Df ** -0.5)),
        }
    _B_in = _B_setup()

    return {
        "A_x": _A_in["x"],
        "A_k_cache": _A_in["k_cache"],
        "A_v_cache": _A_in["v_cache"],
        "A_wq": _A_in["wq"],
        "A_wo": _A_in["wo"],
        "B_x": _B_in["x"],
        "B_w_gate": _B_in["w_gate"],
        "B_w_up": _B_in["w_up"],
        "B_w_down": _B_in["w_down"],
    }

def reference(A_x, A_k_cache, A_v_cache, A_wq, A_wo, B_x, B_w_gate, B_w_up, B_w_down):
    def _A_ref(x, k_cache, v_cache, wq, wo):
        B, Sq, D = x.shape
        H, Dh = 32, 128
        q = (lambda x, *d: x.permute(*d))((x @ wq).reshape(B, Sq, H, Dh), 0, 2, 1, 3)
        scores = torch.einsum("bhqd,bhkd->bhqk", q, k_cache) * (Dh ** -0.5)
        p = _softmax(scores, axis=-1)
        o = torch.einsum("bhqk,bhkd->bhqd", p, v_cache)
        return (lambda x, *d: x.permute(*d))(o, 0, 2, 1, 3).reshape(B, Sq, H * Dh) @ wo

    def _B_ref(x, w_gate, w_up, w_down):
        g = torch.einsum("bsd,df->bsf", x, w_gate)
        u = torch.einsum("bsd,df->bsf", x, w_up)
        h = _gelu(g) * u
        return torch.einsum("bsf,fd->bsd", h, w_down)

    x = A_x
    xn = _layernorm(x, axis=-1)
    return x + _A_ref(xn, A_k_cache, A_v_cache, A_wq, A_wo) + _B_ref(xn, B_w_gate, B_w_up, B_w_down)
```

```asm
; @launch grid=(256,1,1) block=(320,1,1) lds=46464
.amdgcn_target "amdgcn-amd-amdhsa--gfx950"
.text
.globl parallel_sum__mha_block_cached__glu_gated_geglu__decode_kernel
.p2align 8
.type parallel_sum__mha_block_cached__glu_gated_geglu__decode_kernel,@function
parallel_sum__mha_block_cached__glu_gated_geglu__decode_kernel:
    s_cmpk_ge_u32 s2, 0x100
    s_cbranch_scc1 L_exit
    s_load_dwordx16 s[4:19], s[0:1], 0
    s_load_dwordx8 s[20:27], s[0:1], 64
    s_cmp_ge_u32 s2, 8
    s_cbranch_scc1 L_noep0
    s_getpc_b64 s[32:33]
    v_lshlrev_b32 v5, 7, v0
    v_mad_u64_u32 v[8:9], vcc, v5, 1, s[32:33]
    global_load_dword v253, v[8:9], off
L_noep0:
    v_lshrrev_b32 v5, 6, v0
    v_and_b32 v1, 63, v0
    v_readfirstlane_b32 s3, v5
    v_lshrrev_b32 v2, 4, v1
    v_and_b32 v3, 15, v1
    s_and_b32 s28, s2, 7
    s_lshr_b32 s29, s2, 6
    s_lshl2_add_u32 s28, s28, s29
    s_lshr_b32 s29, s2, 3
    s_and_b32 s29, s29, 7
    v_lshlrev_b32 v6, 4, v1
    v_lshlrev_b32 v7, 4, v3
    s_cmp_eq_u32 s3, 4
    s_cbranch_scc1 L_comm0
    s_lshl2_add_u32 s74, s29, s3
    s_lshl_b32 s75, s74, 10
    s_add_u32 s75, s75, s28
    s_lshl_b32 s75, s75, 8
    v_lshl_add_u32 v10, v2, 13, v7
    v_add_u32 v10, s75, v10
    s_movk_i32 s76, 0x8000
    s_waitcnt lgkmcnt(0)
    global_load_dwordx4 v[96:99], v6, s[4:5]
    global_load_dwordx4 v[100:103], v6, s[4:5] offset:1024
    global_load_dwordx4 v[128:131], v10, s[10:11] nt
    v_subrev_u32 v10, s76, v10
    global_load_dwordx4 v[132:135], v10, s[10:11] nt
    v_subrev_u32 v10, s76, v10
    global_load_dwordx4 v[136:139], v10, s[10:11] nt
    v_subrev_u32 v10, s76, v10
    global_load_dwordx4 v[140:143], v10, s[10:11] nt
    v_subrev_u32 v10, s76, v10
    global_load_dwordx4 v[144:147], v10, s[10:11] nt
    v_subrev_u32 v10, s76, v10
    global_load_dwordx4 v[148:151], v10, s[10:11] nt
    v_subrev_u32 v10, s76, v10
    global_load_dwordx4 v[152:155], v10, s[10:11] nt
    v_subrev_u32 v10, s76, v10
    global_load_dwordx4 v[156:159], v10, s[10:11] nt
    s_lshl3_add_u32 s2, s28, s29
    s_load_dword s30, s[26:27], 0
    s_mov_b32 s78, -1
    s_mov_b32 s79, 0
    s_mov_b32 s52, s4
    s_mov_b32 s53, s5
    s_mov_b32 s54, 2048
    s_mov_b32 s55, 0x20000
    s_mov_b32 s56, s26
    s_mov_b32 s57, s27
    s_mov_b32 s58, 2097152
    s_mov_b32 s59, 0x20000
    s_lshl_b32 s74, s74, 5
    v_and_b32 v8, 7, v3
    v_lshl_add_u32 v8, v8, 2, v2
    v_lshlrev_b32 v8, 1, v8
    s_lshl_b32 s75, s74, 1
    buffer_load_ushort v9, v8, s[52:55], s75 offen
    s_mov_b32 s44, s16
    s_mov_b32 s45, s17
    s_mov_b32 s46, 7340032
    s_mov_b32 s47, 0x20000
    s_mov_b32 s48, s18
    s_mov_b32 s49, s19
    s_mov_b32 s50, 7340032
    s_mov_b32 s51, 0x20000
    v_mul_u32_u24 v11, 7168, v2
    v_add_u32 v11, v11, v7
    v_cmp_gt_u32 vcc, 14, v3
    v_mov_b32 v12, 0x80000000
    s_nop 0
    v_cndmask_b32 v11, v12, v11, vcc
    s_mul_i32 s76, s74, 7168
    s_mul_i32 s31, s28, 224
    s_add_u32 s76, s76, s31
    s_mov_b32 s75, s76
    s_mov_b32 s39, 0
    s_bfe_u32 s38, s29, 65536
    s_lshl_b32 s38, s38, 14
    s_or_b32 s39, s39, s38
    s_bfe_u32 s38, s29, 65537
    s_lshl_b32 s38, s38, 15
    s_or_b32 s39, s39, s38
    s_bfe_u32 s38, s29, 65538
    s_lshl_b32 s38, s38, 16
    s_or_b32 s39, s39, s38
    s_lshl_b32 s31, s28, 24
    s_add_u32 s31, s31, s39
    s_sub_u32 s34, 0x1000000, s39
    s_add_u32 s32, s6, s31
    s_addc_u32 s33, s7, 0
    s_mov_b32 s35, 0x20000
    s_add_u32 s36, s8, s31
    s_addc_u32 s37, s9, 0
    s_mov_b32 s39, 0
    s_bfe_u32 s38, s3, 65536
    s_lshl_b32 s38, s38, 12
    s_or_b32 s39, s39, s38
    s_bfe_u32 s38, s3, 65537
    s_lshl_b32 s38, s38, 13
    s_or_b32 s39, s39, s38
    v_and_b32 v4, 1, v2
    v_lshlrev_b32 v4, 8, v4
    v_lshrrev_b32 v5, 1, v2
    v_lshl_add_u32 v4, v5, 9, v4
    v_add3_u32 v4, v4, s39, v7
    s_mov_b32 s72, 0
    v_and_b32 v12, 1, v3
    v_lshrrev_b32 v13, 1, v3
    v_cmp_eq_u32 vcc, 1, v12
    v_mov_b32 v14, 0xffff
    v_mov_b32 v15, 0xffff0000
    v_cndmask_b32 v14, v14, v15, vcc
    v_cmp_eq_u32 vcc, 0, v13
    s_nop 1
    v_cndmask_b32 v120, 0, v14, vcc
    v_cmp_eq_u32 vcc, 1, v13
    s_nop 1
    v_cndmask_b32 v121, 0, v14, vcc
    v_cmp_eq_u32 vcc, 2, v13
    s_nop 1
    v_cndmask_b32 v122, 0, v14, vcc
    v_cmp_eq_u32 vcc, 3, v13
    s_nop 1
    v_cndmask_b32 v123, 0, v14, vcc
    v_cmp_eq_u32 s[82:83], 1, v12
    v_and_b32 v13, 1, v13
    v_cmp_eq_u32 s[80:81], 1, v13
    s_lshl_b32 s31, s3, 9
    v_lshlrev_b32 v225, 5, v3
    v_lshl_add_u32 v225, v2, 4, v225
    v_add_u32 v225, s31, v225
    s_lshl_b32 s31, s3, 13
    v_lshlrev_b32 v224, 2, v1
    v_add_u32 v224, s31, v224
    s_barrier
    s_waitcnt vmcnt(9)
    buffer_load_dwordx4 v[160:163], v11, s[44:47], s75 offen nt
    s_add_u32 s75, s75, 28672
    buffer_load_dwordx4 v[164:167], v11, s[44:47], s75 offen nt
    s_add_u32 s75, s75, 28672
    buffer_load_dwordx4 v[168:171], v11, s[44:47], s75 offen nt
    s_add_u32 s75, s75, 28672
    buffer_load_dwordx4 v[172:175], v11, s[44:47], s75 offen nt
    s_add_u32 s75, s75, 28672
    buffer_load_dwordx4 v[176:179], v11, s[44:47], s75 offen nt
    s_add_u32 s75, s75, 28672
    v_lshlrev_b32 v104, 16, v96
    v_and_b32 v105, 0xffff0000, v96
    v_lshlrev_b32 v106, 16, v97
    v_and_b32 v107, 0xffff0000, v97
    v_lshlrev_b32 v108, 16, v98
    v_and_b32 v109, 0xffff0000, v98
    v_lshlrev_b32 v110, 16, v99
    v_and_b32 v111, 0xffff0000, v99
    v_lshlrev_b32 v112, 16, v100
    v_and_b32 v113, 0xffff0000, v100
    v_lshlrev_b32 v114, 16, v101
    v_and_b32 v115, 0xffff0000, v101
    v_lshlrev_b32 v116, 16, v102
    v_and_b32 v117, 0xffff0000, v102
    v_lshlrev_b32 v118, 16, v103
    v_and_b32 v119, 0xffff0000, v103
    v_add_f32 v12, v104, v105
    v_add_f32 v13, v106, v107
    v_add_f32 v14, v108, v109
    v_add_f32 v15, v110, v111
    v_add_f32 v16, v112, v113
    v_add_f32 v17, v114, v115
    v_add_f32 v18, v116, v117
    v_add_f32 v19, v118, v119
    v_add_f32 v12, v12, v13
    v_add_f32 v14, v14, v15
    v_add_f32 v16, v16, v17
    v_add_f32 v18, v18, v19
    v_add_f32 v12, v12, v14
    v_add_f32 v16, v16, v18
    v_add_f32 v12, v12, v16
    s_nop 1
    v_add_f32_dpp v12, v12, v12 row_ror:8 row_mask:0xf bank_mask:0xf
    s_nop 1
    v_add_f32_dpp v12, v12, v12 row_ror:4 row_mask:0xf bank_mask:0xf
    s_nop 1
    v_add_f32_dpp v12, v12, v12 row_ror:2 row_mask:0xf bank_mask:0xf
    s_nop 1
    v_add_f32_dpp v12, v12, v12 row_ror:1 row_mask:0xf bank_mask:0xf
    v_mov_b32 v13, v12
    s_nop 1
    v_permlane16_swap_b32 v12, v13
    v_add_f32 v12, v12, v13
    v_mov_b32 v13, v12
    s_nop 1
    v_permlane32_swap_b32 v12, v13
    v_add_f32 v12, v12, v13
    v_mul_f32 v12, 0x3a800000, v12
    v_sub_f32 v104, v104, v12
    v_sub_f32 v105, v105, v12
    v_sub_f32 v106, v106, v12
    v_sub_f32 v107, v107, v12
    v_sub_f32 v108, v108, v12
    v_sub_f32 v109, v109, v12
    v_sub_f32 v110, v110, v12
    v_sub_f32 v111, v111, v12
    v_sub_f32 v112, v112, v12
    v_sub_f32 v113, v113, v12
    v_sub_f32 v114, v114, v12
    v_sub_f32 v115, v115, v12
    v_sub_f32 v116, v116, v12
    v_sub_f32 v117, v117, v12
    v_sub_f32 v118, v118, v12
    v_sub_f32 v119, v119, v12
    v_mul_f32 v14, v104, v104
    v_mul_f32 v15, v105, v105
    v_mul_f32 v16, v106, v106
    v_mul_f32 v17, v107, v107
    v_fmac_f32 v14, v108, v108
    v_fmac_f32 v15, v109, v109
    v_fmac_f32 v16, v110, v110
    v_fmac_f32 v17, v111, v111
    v_fmac_f32 v14, v112, v112
    v_fmac_f32 v15, v113, v113
    v_fmac_f32 v16, v114, v114
    v_fmac_f32 v17, v115, v115
    v_fmac_f32 v14, v116, v116
    v_fmac_f32 v15, v117, v117
    v_fmac_f32 v16, v118, v118
    v_fmac_f32 v17, v119, v119
    v_add_f32 v14, v14, v15
    v_add_f32 v16, v16, v17
    v_add_f32 v14, v14, v16
    s_nop 1
    v_add_f32_dpp v14, v14, v14 row_ror:8 row_mask:0xf bank_mask:0xf
    s_nop 1
    v_add_f32_dpp v14, v14, v14 row_ror:4 row_mask:0xf bank_mask:0xf
    s_nop 1
    v_add_f32_dpp v14, v14, v14 row_ror:2 row_mask:0xf bank_mask:0xf
    s_nop 1
    v_add_f32_dpp v14, v14, v14 row_ror:1 row_mask:0xf bank_mask:0xf
    v_mov_b32 v13, v14
    s_nop 1
    v_permlane16_swap_b32 v14, v13
    v_add_f32 v14, v14, v13
    v_mov_b32 v13, v14
    s_nop 1
    v_permlane32_swap_b32 v14, v13
    v_add_f32 v14, v14, v13
    v_mul_f32 v14, 0x3a800000, v14
    v_cvt_pk_bf16_f32 v14, v14, v14
    v_and_b32 v14, 0xffff0000, v14
    v_cvt_pk_bf16_f32 v12, v12, v12
    v_and_b32 v12, 0xffff0000, v12
    v_add_f32 v14, 0x3727c5ac, v14
    v_cvt_pk_bf16_f32 v14, v14, v14
    v_and_b32 v14, 0xffff0000, v14
    v_sqrt_f32 v14, v14
    s_nop 0
    v_cvt_pk_bf16_f32 v14, v14, v14
    v_and_b32 v14, 0xffff0000, v14
    v_rcp_f32 v14, v14
    s_waitcnt vmcnt(5)
    buffer_load_dwordx4 v[180:183], v11, s[44:47], s75 offen nt
    s_add_u32 s75, s75, 28672
    buffer_load_dwordx4 v[184:187], v11, s[44:47], s75 offen nt
    s_add_u32 s75, s75, 28672
    buffer_load_dwordx4 v[188:191], v11, s[44:47], s75 offen nt
    s_add_u32 s75, s75, 28672
    v_lshlrev_b32 v9, 16, v9
    v_sub_f32 v9, v9, v12
    v_cvt_pk_bf16_f32 v9, v9, v9
    v_and_b32 v9, 0xffff0000, v9
    v_mul_f32 v9, v9, v14
    v_cvt_pk_bf16_f32 v124, v9, v9
    s_nop 1
    v_and_b32_dpp v24, v124, v120 row_newbcast:0 row_mask:0xf bank_mask:0xf
    v_and_b32_dpp v25, v124, v121 row_newbcast:0 row_mask:0xf bank_mask:0xf
    v_and_b32_dpp v26, v124, v122 row_newbcast:0 row_mask:0xf bank_mask:0xf
    v_and_b32_dpp v27, v124, v123 row_newbcast:0 row_mask:0xf bank_mask:0xf
    v_and_b32_dpp v28, v124, v120 row_newbcast:1 row_mask:0xf bank_mask:0xf
    v_and_b32_dpp v29, v124, v121 row_newbcast:1 row_mask:0xf bank_mask:0xf
    v_and_b32_dpp v30, v124, v122 row_newbcast:1 row_mask:0xf bank_mask:0xf
    v_and_b32_dpp v31, v124, v123 row_newbcast:1 row_mask:0xf bank_mask:0xf
    v_mfma_f32_16x16x32_bf16 v[12:15], v[24:27], v[128:131], 0
    v_and_b32_dpp v24, v124, v120 row_newbcast:2 row_mask:0xf bank_mask:0xf
    v_and_b32_dpp v25, v124, v121 row_newbcast:2 row_mask:0xf bank_mask:0xf
    v_and_b32_dpp v26, v124, v122 row_newbcast:2 row_mask:0xf bank_mask:0xf
    v_and_b32_dpp v27, v124, v123 row_newbcast:2 row_mask:0xf bank_mask:0xf
    v_mfma_f32_16x16x32_bf16 v[12:15], v[28:31], v[132:135], v[12:15]
    v_and_b32_dpp v28, v124, v120 row_newbcast:3 row_mask:0xf bank_mask:0xf
    v_and_b32_dpp v29, v124, v121 row_newbcast:3 row_mask:0xf bank_mask:0xf
    v_and_b32_dpp v30, v124, v122 row_newbcast:3 row_mask:0xf bank_mask:0xf
    v_and_b32_dpp v31, v124, v123 row_newbcast:3 row_mask:0xf bank_mask:0xf
    v_mfma_f32_16x16x32_bf16 v[12:15], v[24:27], v[136:139], v[12:15]
    v_and_b32_dpp v24, v124, v120 row_newbcast:4 row_mask:0xf bank_mask:0xf
    v_and_b32_dpp v25, v124, v121 row_newbcast:4 row_mask:0xf bank_mask:0xf
    v_and_b32_dpp v26, v124, v122 row_newbcast:4 row_mask:0xf bank_mask:0xf
    v_and_b32_dpp v27, v124, v123 row_newbcast:4 row_mask:0xf bank_mask:0xf
    v_mfma_f32_16x16x32_bf16 v[12:15], v[28:31], v[140:143], v[12:15]
    v_and_b32_dpp v28, v124, v120 row_newbcast:5 row_mask:0xf bank_mask:0xf
    v_and_b32_dpp v29, v124, v121 row_newbcast:5 row_mask:0xf bank_mask:0xf
    v_and_b32_dpp v30, v124, v122 row_newbcast:5 row_mask:0xf bank_mask:0xf
    v_and_b32_dpp v31, v124, v123 row_newbcast:5 row_mask:0xf bank_mask:0xf
    v_mfma_f32_16x16x32_bf16 v[12:15], v[24:27], v[144:147], v[12:15]
    v_and_b32_dpp v24, v124, v120 row_newbcast:6 row_mask:0xf bank_mask:0xf
    v_and_b32_dpp v25, v124, v121 row_newbcast:6 row_mask:0xf bank_mask:0xf
    v_and_b32_dpp v26, v124, v122 row_newbcast:6 row_mask:0xf bank_mask:0xf
    v_and_b32_dpp v27, v124, v123 row_newbcast:6 row_mask:0xf bank_mask:0xf
    v_mfma_f32_16x16x32_bf16 v[12:15], v[28:31], v[148:151], v[12:15]
    v_and_b32_dpp v28, v124, v120 row_newbcast:7 row_mask:0xf bank_mask:0xf
    v_and_b32_dpp v29, v124, v121 row_newbcast:7 row_mask:0xf bank_mask:0xf
    v_and_b32_dpp v30, v124, v122 row_newbcast:7 row_mask:0xf bank_mask:0xf
    v_and_b32_dpp v31, v124, v123 row_newbcast:7 row_mask:0xf bank_mask:0xf
    v_mfma_f32_16x16x32_bf16 v[12:15], v[24:27], v[152:155], v[12:15]
    s_nop 0
    v_mfma_f32_16x16x32_bf16 v[12:15], v[28:31], v[156:159], v[12:15]
    s_mov_b64 exec, s[78:79]
    s_nop 6
    ds_write_b128 v225, v[12:15] offset:32768
    s_mov_b64 exec, -1
    s_lshl_b32 s31, s3, 2
    v_mov_b32 v16, s31
    v_mov_b32 v17, 1
    ds_write_b32 v16, v17 offset:46368
    s_waitcnt vmcnt(7)
    buffer_load_dwordx4 v[192:195], v11, s[48:51], s76 offen nt
    s_add_u32 s76, s76, 28672
    s_waitcnt vmcnt(7)
    buffer_load_dwordx4 v[196:199], v11, s[48:51], s76 offen nt
    s_add_u32 s76, s76, 28672
    s_waitcnt vmcnt(7)
    buffer_load_dwordx4 v[200:203], v11, s[48:51], s76 offen nt
    s_add_u32 s76, s76, 28672
    s_waitcnt vmcnt(7)
    buffer_load_dwordx4 v[204:207], v11, s[48:51], s76 offen nt
    s_add_u32 s76, s76, 28672
    s_waitcnt vmcnt(7)
    buffer_load_dwordx4 v[208:211], v11, s[48:51], s76 offen nt
    s_add_u32 s76, s76, 28672
    s_waitcnt vmcnt(7)
    buffer_load_dwordx4 v[212:215], v11, s[48:51], s76 offen nt
    s_add_u32 s76, s76, 28672
    s_waitcnt vmcnt(7)
    buffer_load_dwordx4 v[216:219], v11, s[48:51], s76 offen nt
    s_add_u32 s76, s76, 28672
    s_waitcnt vmcnt(7)
    buffer_load_dwordx4 v[220:223], v11, s[48:51], s76 offen nt
    s_add_u32 s76, s76, 28672
    s_waitcnt vmcnt(7)
    buffer_load_dwordx4 v[32:35], v4, s[32:35], s72 offen nt
    s_add_u32 s72, s72, 1024
    v_and_b32_dpp v24, v124, v120 row_newbcast:0 row_mask:0xf bank_mask:0xf
    v_and_b32_dpp v25, v124, v121 row_newbcast:0 row_mask:0xf bank_mask:0xf
    v_and_b32_dpp v26, v124, v122 row_newbcast:0 row_mask:0xf bank_mask:0xf
    v_and_b32_dpp v27, v124, v123 row_newbcast:0 row_mask:0xf bank_mask:0xf
    v_and_b32_dpp v28, v124, v120 row_newbcast:1 row_mask:0xf bank_mask:0xf
    v_and_b32_dpp v29, v124, v121 row_newbcast:1 row_mask:0xf bank_mask:0xf
    v_and_b32_dpp v30, v124, v122 row_newbcast:1 row_mask:0xf bank_mask:0xf
    v_and_b32_dpp v31, v124, v123 row_newbcast:1 row_mask:0xf bank_mask:0xf
    v_mfma_f32_16x16x32_bf16 v[16:19], v[24:27], v[160:163], 0
    v_and_b32_dpp v24, v124, v120 row_newbcast:2 row_mask:0xf bank_mask:0xf
    v_and_b32_dpp v25, v124, v121 row_newbcast:2 row_mask:0xf bank_mask:0xf
    v_and_b32_dpp v26, v124, v122 row_newbcast:2 row_mask:0xf bank_mask:0xf
    v_and_b32_dpp v27, v124, v123 row_newbcast:2 row_mask:0xf bank_mask:0xf
    v_mfma_f32_16x16x32_bf16 v[16:19], v[28:31], v[164:167], v[16:19]
    v_and_b32_dpp v28, v124, v120 row_newbcast:3 row_mask:0xf bank_mask:0xf
    v_and_b32_dpp v29, v124, v121 row_newbcast:3 row_mask:0xf bank_mask:0xf
    v_and_b32_dpp v30, v124, v122 row_newbcast:3 row_mask:0xf bank_mask:0xf
    v_and_b32_dpp v31, v124, v123 row_newbcast:3 row_mask:0xf bank_mask:0xf
    v_mfma_f32_16x16x32_bf16 v[16:19], v[24:27], v[168:171], v[16:19]
    v_and_b32_dpp v24, v124, v120 row_newbcast:4 row_mask:0xf bank_mask:0xf
    v_and_b32_dpp v25, v124, v121 row_newbcast:4 row_mask:0xf bank_mask:0xf
    v_and_b32_dpp v26, v124, v122 row_newbcast:4 row_mask:0xf bank_mask:0xf
    v_and_b32_dpp v27, v124, v123 row_newbcast:4 row_mask:0xf bank_mask:0xf
    v_mfma_f32_16x16x32_bf16 v[16:19], v[28:31], v[172:175], v[16:19]
    v_and_b32_dpp v28, v124, v120 row_newbcast:5 row_mask:0xf bank_mask:0xf
    v_and_b32_dpp v29, v124, v121 row_newbcast:5 row_mask:0xf bank_mask:0xf
    v_and_b32_dpp v30, v124, v122 row_newbcast:5 row_mask:0xf bank_mask:0xf
    v_and_b32_dpp v31, v124, v123 row_newbcast:5 row_mask:0xf bank_mask:0xf
    v_mfma_f32_16x16x32_bf16 v[16:19], v[24:27], v[176:179], v[16:19]
    v_and_b32_dpp v24, v124, v120 row_newbcast:6 row_mask:0xf bank_mask:0xf
    v_and_b32_dpp v25, v124, v121 row_newbcast:6 row_mask:0xf bank_mask:0xf
    v_and_b32_dpp v26, v124, v122 row_newbcast:6 row_mask:0xf bank_mask:0xf
    v_and_b32_dpp v27, v124, v123 row_newbcast:6 row_mask:0xf bank_mask:0xf
    v_mfma_f32_16x16x32_bf16 v[16:19], v[28:31], v[180:183], v[16:19]
    v_and_b32_dpp v28, v124, v120 row_newbcast:7 row_mask:0xf bank_mask:0xf
    v_and_b32_dpp v29, v124, v121 row_newbcast:7 row_mask:0xf bank_mask:0xf
    v_and_b32_dpp v30, v124, v122 row_newbcast:7 row_mask:0xf bank_mask:0xf
    v_and_b32_dpp v31, v124, v123 row_newbcast:7 row_mask:0xf bank_mask:0xf
    v_mfma_f32_16x16x32_bf16 v[16:19], v[24:27], v[184:187], v[16:19]
    s_nop 0
    v_mfma_f32_16x16x32_bf16 v[16:19], v[28:31], v[188:191], v[16:19]
    s_waitcnt vmcnt(7)
    buffer_load_dwordx4 v[36:39], v4, s[32:35], s72 offen nt
    s_add_u32 s72, s72, 1024
    s_waitcnt vmcnt(7)
    buffer_load_dwordx4 v[40:43], v4, s[32:35], s72 offen nt
    s_add_u32 s72, s72, 1024
    s_waitcnt vmcnt(7)
    buffer_load_dwordx4 v[44:47], v4, s[32:35], s72 offen nt
    s_add_u32 s72, s72, 521216
    s_waitcnt vmcnt(7)
    buffer_load_dwordx4 v[48:51], v4, s[32:35], s72 offen nt
    s_add_u32 s72, s72, 1024
    s_waitcnt vmcnt(7)
    buffer_load_dwordx4 v[52:55], v4, s[32:35], s72 offen nt
    s_add_u32 s72, s72, 1024
    s_waitcnt vmcnt(7)
    buffer_load_dwordx4 v[56:59], v4, s[32:35], s72 offen nt
    s_add_u32 s72, s72, 1024
    s_waitcnt vmcnt(7)
    buffer_load_dwordx4 v[60:63], v4, s[32:35], s72 offen nt
    s_add_u32 s72, s72, 3666944
    v_and_b32_dpp v24, v124, v120 row_newbcast:0 row_mask:0xf bank_mask:0xf
    v_and_b32_dpp v25, v124, v121 row_newbcast:0 row_mask:0xf bank_mask:0xf
    v_and_b32_dpp v26, v124, v122 row_newbcast:0 row_mask:0xf bank_mask:0xf
    v_and_b32_dpp v27, v124, v123 row_newbcast:0 row_mask:0xf bank_mask:0xf
    v_and_b32_dpp v28, v124, v120 row_newbcast:1 row_mask:0xf bank_mask:0xf
    v_and_b32_dpp v29, v124, v121 row_newbcast:1 row_mask:0xf bank_mask:0xf
    v_and_b32_dpp v30, v124, v122 row_newbcast:1 row_mask:0xf bank_mask:0xf
    v_and_b32_dpp v31, v124, v123 row_newbcast:1 row_mask:0xf bank_mask:0xf
    v_mfma_f32_16x16x32_bf16 v[20:23], v[24:27], v[192:195], 0
    v_and_b32_dpp v24, v124, v120 row_newbcast:2 row_mask:0xf bank_mask:0xf
    v_and_b32_dpp v25, v124, v121 row_newbcast:2 row_mask:0xf bank_mask:0xf
    v_and_b32_dpp v26, v124, v122 row_newbcast:2 row_mask:0xf bank_mask:0xf
    v_and_b32_dpp v27, v124, v123 row_newbcast:2 row_mask:0xf bank_mask:0xf
    v_mfma_f32_16x16x32_bf16 v[20:23], v[28:31], v[196:199], v[20:23]
    v_and_b32_dpp v28, v124, v120 row_newbcast:3 row_mask:0xf bank_mask:0xf
    v_and_b32_dpp v29, v124, v121 row_newbcast:3 row_mask:0xf bank_mask:0xf
    v_and_b32_dpp v30, v124, v122 row_newbcast:3 row_mask:0xf bank_mask:0xf
    v_and_b32_dpp v31, v124, v123 row_newbcast:3 row_mask:0xf bank_mask:0xf
    v_mfma_f32_16x16x32_bf16 v[20:23], v[24:27], v[200:203], v[20:23]
    v_and_b32_dpp v24, v124, v120 row_newbcast:4 row_mask:0xf bank_mask:0xf
    v_and_b32_dpp v25, v124, v121 row_newbcast:4 row_mask:0xf bank_mask:0xf
    v_and_b32_dpp v26, v124, v122 row_newbcast:4 row_mask:0xf bank_mask:0xf
    v_and_b32_dpp v27, v124, v123 row_newbcast:4 row_mask:0xf bank_mask:0xf
    v_mfma_f32_16x16x32_bf16 v[20:23], v[28:31], v[204:207], v[20:23]
    v_and_b32_dpp v28, v124, v120 row_newbcast:5 row_mask:0xf bank_mask:0xf
    v_and_b32_dpp v29, v124, v121 row_newbcast:5 row_mask:0xf bank_mask:0xf
    v_and_b32_dpp v30, v124, v122 row_newbcast:5 row_mask:0xf bank_mask:0xf
    v_and_b32_dpp v31, v124, v123 row_newbcast:5 row_mask:0xf bank_mask:0xf
    v_mfma_f32_16x16x32_bf16 v[20:23], v[24:27], v[208:211], v[20:23]
    v_and_b32_dpp v24, v124, v120 row_newbcast:6 row_mask:0xf bank_mask:0xf
    v_and_b32_dpp v25, v124, v121 row_newbcast:6 row_mask:0xf bank_mask:0xf
    v_and_b32_dpp v26, v124, v122 row_newbcast:6 row_mask:0xf bank_mask:0xf
    v_and_b32_dpp v27, v124, v123 row_newbcast:6 row_mask:0xf bank_mask:0xf
    v_mfma_f32_16x16x32_bf16 v[20:23], v[28:31], v[212:215], v[20:23]
    v_and_b32_dpp v28, v124, v120 row_newbcast:7 row_mask:0xf bank_mask:0xf
    v_and_b32_dpp v29, v124, v121 row_newbcast:7 row_mask:0xf bank_mask:0xf
    v_and_b32_dpp v30, v124, v122 row_newbcast:7 row_mask:0xf bank_mask:0xf
    v_and_b32_dpp v31, v124, v123 row_newbcast:7 row_mask:0xf bank_mask:0xf
    v_mfma_f32_16x16x32_bf16 v[20:23], v[24:27], v[216:219], v[20:23]
    s_nop 0
    v_mfma_f32_16x16x32_bf16 v[20:23], v[28:31], v[220:223], v[20:23]
    s_mov_b64 exec, s[78:79]
    ds_write_b128 v225, v[16:19] offset:34816
    s_mov_b64 exec, -1
    s_mov_b64 exec, s[78:79]
    s_nop 3
    ds_write_b128 v225, v[20:23] offset:36864
    s_mov_b64 exec, -1
    s_lshl_b32 s31, s3, 2
    v_mov_b32 v16, s31
    v_mov_b32 v17, 1
    ds_write_b32 v16, v17 offset:46384
    s_waitcnt vmcnt(7)
    buffer_load_dwordx4 v[64:67], v4, s[32:35], s72 offen nt
    s_add_u32 s72, s72, 1024
    s_waitcnt vmcnt(7)
    buffer_load_dwordx4 v[68:71], v4, s[32:35], s72 offen nt
    s_add_u32 s72, s72, 1024
    s_waitcnt vmcnt(7)
    buffer_load_dwordx4 v[72:75], v4, s[32:35], s72 offen nt
    s_add_u32 s72, s72, 1024
    s_waitcnt vmcnt(7)
    buffer_load_dwordx4 v[76:79], v4, s[32:35], s72 offen nt
    s_add_u32 s72, s72, 521216
    s_waitcnt vmcnt(7)
    buffer_load_dwordx4 v[80:83], v4, s[32:35], s72 offen nt
    s_add_u32 s72, s72, 1024
    s_waitcnt vmcnt(7)
    buffer_load_dwordx4 v[84:87], v4, s[32:35], s72 offen nt
    s_add_u32 s72, s72, 1024
    s_waitcnt vmcnt(7)
    buffer_load_dwordx4 v[88:91], v4, s[32:35], s72 offen nt
    s_add_u32 s72, s72, 1024
    s_waitcnt vmcnt(7)
    buffer_load_dwordx4 v[92:95], v4, s[32:35], s72 offen nt
    s_add_u32 s72, s72, 3666944
    s_waitcnt lgkmcnt(0)
    s_mov_b32 s40, s12
    s_mov_b32 s41, s13
    s_mov_b32 s42, 8388608
    s_mov_b32 s43, 0x20000
    v_lshl_add_u32 v240, v2, 14, v7
    s_lshl_b32 s31, s28, 2
    s_add_u32 s31, s31, s3
    s_lshl_b32 s75, s31, 16
    s_lshl_b32 s31, s29, 8
    s_add_u32 s75, s75, s31
    v_and_b32 v232, 7, v3
    v_lshrrev_b32 v233, 3, v3
    s_lshl_b32 s31, s28, 13
    s_add_u32 s31, s31, 589824
    v_lshlrev_b32 v232, 10, v232
    v_add_u32 v232, s31, v232
    v_lshlrev_b32 v233, 4, v233
    v_lshl_add_u32 v233, v2, 5, v233
    s_lshl_b32 s31, s3, 7
    v_add3_u32 v233, v233, s31, v232
    s_add_u32 s30, s30, 1
    s_waitcnt vmcnt(7)
    buffer_load_dwordx4 v[128:131], v4, s[32:35], s72 offen nt
    s_add_u32 s72, s72, 1024
    s_waitcnt vmcnt(7)
    buffer_load_dwordx4 v[132:135], v4, s[32:35], s72 offen nt
    s_add_u32 s72, s72, 1024
    s_waitcnt vmcnt(7)
    buffer_load_dwordx4 v[136:139], v4, s[32:35], s72 offen nt
    s_add_u32 s72, s72, 1024
    s_waitcnt vmcnt(7)
    buffer_load_dwordx4 v[140:143], v4, s[32:35], s72 offen nt
    s_add_u32 s72, s72, 521216
    s_waitcnt vmcnt(7)
    buffer_load_dwordx4 v[144:147], v4, s[32:35], s72 offen nt
    s_add_u32 s72, s72, 1024
    s_waitcnt vmcnt(7)
    buffer_load_dwordx4 v[148:151], v4, s[32:35], s72 offen nt
    s_add_u32 s72, s72, 1024
    s_waitcnt vmcnt(7)
    buffer_load_dwordx4 v[152:155], v4, s[32:35], s72 offen nt
    s_add_u32 s72, s72, 1024
    s_waitcnt vmcnt(7)
    buffer_load_dwordx4 v[156:159], v4, s[32:35], s72 offen nt
    s_add_u32 s72, s72, 3666944
    s_waitcnt vmcnt(7)
    buffer_load_dwordx4 v[160:163], v4, s[32:35], s72 offen nt
    s_add_u32 s72, s72, 1024
    s_waitcnt vmcnt(7)
    buffer_load_dwordx4 v[164:167], v4, s[32:35], s72 offen nt
    s_add_u32 s72, s72, 1024
    s_waitcnt vmcnt(7)
    buffer_load_dwordx4 v[168:171], v4, s[32:35], s72 offen nt
    s_add_u32 s72, s72, 1024
    s_waitcnt vmcnt(7)
    buffer_load_dwordx4 v[172:175], v4, s[32:35], s72 offen nt
    s_add_u32 s72, s72, 521216
    s_waitcnt vmcnt(7)
    buffer_load_dwordx4 v[176:179], v4, s[32:35], s72 offen nt
    s_add_u32 s72, s72, 1024
    s_waitcnt vmcnt(7)
    buffer_load_dwordx4 v[180:183], v4, s[32:35], s72 offen nt
    s_add_u32 s72, s72, 1024
    s_waitcnt vmcnt(7)
    buffer_load_dwordx4 v[184:187], v4, s[32:35], s72 offen nt
    s_add_u32 s72, s72, 1024
    s_waitcnt vmcnt(7)
    buffer_load_dwordx4 v[188:191], v4, s[32:35], s72 offen nt
    s_or_b32 s72, s72, 4291428351
    s_add_u32 s72, s72, 1
    s_and_b32 s72, s72, 3538944
    v_mov_b32 v126, 0xff800000
    v_mov_b32 v127, 0
    s_mov_b32 s76, 1035273459
    v_mov_b32 v247, 0
    s_nop 2
L_qw:
    ds_read_b32 v16, v247 offset:46400
    ds_read_b128 v[8:11], v7 offset:45056
    s_waitcnt lgkmcnt(0)
    v_readfirstlane_b32 s31, v16
    s_nop 3
    s_cmp_eq_u32 s31, 1
    s_cbranch_scc1 L_qw_ok
    s_sleep 1
    s_branch L_qw
L_qw_ok:
    s_mov_b32 s70, 1
    s_mov_b32 s69, 0
    s_mov_b32 s67, 0
    s_lshl_b32 s31, s3, 3
    v_mov_b32 v246, s31
    v_mov_b32 v247, 0
    s_mov_b32 s73, 16
L_kloop:
    s_cmp_lg_u32 s73, 1
    s_cbranch_scc1 L_knosw
    s_mov_b32 s32, s36
    s_mov_b32 s33, s37
    s_mov_b32 s72, 0
L_knosw:
    s_cmp_eq_u32 s70, 1
    s_cbranch_scc1 L_v1_1
    s_cmp_eq_u32 s70, 2
    s_cbranch_scc1 L_v1_2
    s_cmp_eq_u32 s70, 3
    s_cbranch_scc1 L_v1_3
    v_dot2_f32_bf16 v12, v32, v8, 0
    v_dot2_f32_bf16 v12, v33, v9, v12
    v_dot2_f32_bf16 v12, v34, v10, v12
    v_dot2_f32_bf16 v12, v35, v11, v12
    s_waitcnt vmcnt(3)
    buffer_load_dwordx4 v[32:35], v4, s[32:35], s72 offen nt
    s_add_u32 s72, s72, 1024
    v_dot2_f32_bf16 v13, v36, v8, 0
    v_dot2_f32_bf16 v13, v37, v9, v13
    v_dot2_f32_bf16 v13, v38, v10, v13
    v_dot2_f32_bf16 v13, v39, v11, v13
    s_waitcnt vmcnt(3)
    buffer_load_dwordx4 v[36:39], v4, s[32:35], s72 offen nt
    s_add_u32 s72, s72, 1024
    v_dot2_f32_bf16 v14, v40, v8, 0
    v_dot2_f32_bf16 v14, v41, v9, v14
    v_dot2_f32_bf16 v14, v42, v10, v14
    v_dot2_f32_bf16 v14, v43, v11, v14
    s_waitcnt vmcnt(3)
    buffer_load_dwordx4 v[40:43], v4, s[32:35], s72 offen nt
    s_add_u32 s72, s72, 1024
    v_dot2_f32_bf16 v15, v44, v8, 0
    v_dot2_f32_bf16 v15, v45, v9, v15
    v_dot2_f32_bf16 v15, v46, v10, v15
    v_dot2_f32_bf16 v15, v47, v11, v15
    s_waitcnt vmcnt(3)
    buffer_load_dwordx4 v[44:47], v4, s[32:35], s72 offen nt
    s_add_u32 s72, s72, 521216
    v_add_f32_dpp v16, v12, v12 row_ror:8 row_mask:0xf bank_mask:0x3
    v_add_f32_dpp v17, v14, v14 row_ror:8 row_mask:0xf bank_mask:0x3
    s_nop 0
    v_add_f32_dpp v16, v13, v13 row_ror:8 row_mask:0xf bank_mask:0xc
    v_add_f32_dpp v17, v15, v15 row_ror:8 row_mask:0xf bank_mask:0xc
    s_nop 0
    v_add_f32_dpp v20, v16, v16 row_shl:4 row_mask:0xf bank_mask:0x5
    s_nop 1
    v_add_f32_dpp v20, v17, v17 row_shr:4 row_mask:0xf bank_mask:0xa
    v_dot2_f32_bf16 v12, v48, v8, 0
    v_dot2_f32_bf16 v12, v49, v9, v12
    v_dot2_f32_bf16 v12, v50, v10, v12
    v_dot2_f32_bf16 v12, v51, v11, v12
    s_waitcnt vmcnt(3)
    buffer_load_dwordx4 v[48:51], v4, s[32:35], s72 offen nt
    s_add_u32 s72, s72, 1024
    v_dot2_f32_bf16 v13, v52, v8, 0
    v_dot2_f32_bf16 v13, v53, v9, v13
    v_dot2_f32_bf16 v13, v54, v10, v13
    v_dot2_f32_bf16 v13, v55, v11, v13
    s_waitcnt vmcnt(3)
    buffer_load_dwordx4 v[52:55], v4, s[32:35], s72 offen nt
    s_add_u32 s72, s72, 1024
    v_dot2_f32_bf16 v14, v56, v8, 0
    v_dot2_f32_bf16 v14, v57, v9, v14
    v_dot2_f32_bf16 v14, v58, v10, v14
    v_dot2_f32_bf16 v14, v59, v11, v14
    s_waitcnt vmcnt(3)
    buffer_load_dwordx4 v[56:59], v4, s[32:35], s72 offen nt
    s_add_u32 s72, s72, 1024
    s_memrealtime s[64:65]
    ds_read_b64 v[242:243], v247 offset:46416
    v_dot2_f32_bf16 v15, v60, v8, 0
    v_dot2_f32_bf16 v15, v61, v9, v15
    v_dot2_f32_bf16 v15, v62, v10, v15
    v_dot2_f32_bf16 v15, v63, v11, v15
    s_waitcnt vmcnt(3)
    buffer_load_dwordx4 v[60:63], v4, s[32:35], s72 offen nt
    s_add_u32 s72, s72, 3666944
    v_add_f32_dpp v16, v12, v12 row_ror:8 row_mask:0xf bank_mask:0x3
    v_add_f32_dpp v17, v14, v14 row_ror:8 row_mask:0xf bank_mask:0x3
    s_nop 0
    v_add_f32_dpp v16, v13, v13 row_ror:8 row_mask:0xf bank_mask:0xc
    v_add_f32_dpp v17, v15, v15 row_ror:8 row_mask:0xf bank_mask:0xc
    s_nop 0
    v_add_f32_dpp v21, v16, v16 row_shl:4 row_mask:0xf bank_mask:0x5
    s_nop 1
    v_add_f32_dpp v21, v17, v17 row_shr:4 row_mask:0xf bank_mask:0xa
    v_dot2_f32_bf16 v12, v64, v8, 0
    v_dot2_f32_bf16 v12, v65, v9, v12
    v_dot2_f32_bf16 v12, v66, v10, v12
    v_dot2_f32_bf16 v12, v67, v11, v12
    s_waitcnt vmcnt(3)
    buffer_load_dwordx4 v[64:67], v4, s[32:35], s72 offen nt
    s_add_u32 s72, s72, 1024
    v_dot2_f32_bf16 v13, v68, v8, 0
    v_dot2_f32_bf16 v13, v69, v9, v13
    v_dot2_f32_bf16 v13, v70, v10, v13
    v_dot2_f32_bf16 v13, v71, v11, v13
    s_waitcnt vmcnt(3)
    buffer_load_dwordx4 v[68:71], v4, s[32:35], s72 offen nt
    s_add_u32 s72, s72, 1024
    v_dot2_f32_bf16 v14, v72, v8, 0
    v_dot2_f32_bf16 v14, v73, v9, v14
    v_dot2_f32_bf16 v14, v74, v10, v14
    v_dot2_f32_bf16 v14, v75, v11, v14
    s_waitcnt vmcnt(3)
    buffer_load_dwordx4 v[72:75], v4, s[32:35], s72 offen nt
    s_add_u32 s72, s72, 1024
    v_dot2_f32_bf16 v15, v76, v8, 0
    v_dot2_f32_bf16 v15, v77, v9, v15
    v_dot2_f32_bf16 v15, v78, v10, v15
    v_dot2_f32_bf16 v15, v79, v11, v15
    s_waitcnt vmcnt(3)
    buffer_load_dwordx4 v[76:79], v4, s[32:35], s72 offen nt
    s_add_u32 s72, s72, 521216
    v_add_f32_dpp v16, v12, v12 row_ror:8 row_mask:0xf bank_mask:0x3
    v_add_f32_dpp v17, v14, v14 row_ror:8 row_mask:0xf bank_mask:0x3
    s_nop 0
    v_add_f32_dpp v16, v13, v13 row_ror:8 row_mask:0xf bank_mask:0xc
    v_add_f32_dpp v17, v15, v15 row_ror:8 row_mask:0xf bank_mask:0xc
    s_nop 0
    v_add_f32_dpp v22, v16, v16 row_shl:4 row_mask:0xf bank_mask:0x5
    s_nop 1
    v_add_f32_dpp v22, v17, v17 row_shr:4 row_mask:0xf bank_mask:0xa
    s_waitcnt lgkmcnt(0)
    v_readfirstlane_b32 s62, v242
    v_readfirstlane_b32 s63, v243
    s_sub_u32 s68, s64, s69
    s_add_u32 s69, s69, 216
    s_add_u32 s67, s67, 1
    v_mov_b32 v244, s68
    v_mov_b32 v245, s67
    ds_write_b64 v246, v[244:245] offset:46432
    s_sub_u32 s68, s68, s62
    s_and_b32 s68, s68, s63
    s_mov_b32 s70, 0
    s_cmp_gt_i32 s68, -60
    s_addc_u32 s70, s70, 0
    s_cmp_gt_i32 s68, 25
    s_addc_u32 s70, s70, 0
    s_cmp_gt_i32 s68, 90
    s_addc_u32 s70, s70, 0
    v_dot2_f32_bf16 v12, v80, v8, 0
    v_dot2_f32_bf16 v12, v81, v9, v12
    v_dot2_f32_bf16 v12, v82, v10, v12
    v_dot2_f32_bf16 v12, v83, v11, v12
    s_waitcnt vmcnt(3)
    buffer_load_dwordx4 v[80:83], v4, s[32:35], s72 offen nt
    s_add_u32 s72, s72, 1024
    v_dot2_f32_bf16 v13, v84, v8, 0
    v_dot2_f32_bf16 v13, v85, v9, v13
    v_dot2_f32_bf16 v13, v86, v10, v13
    v_dot2_f32_bf16 v13, v87, v11, v13
    s_waitcnt vmcnt(3)
    buffer_load_dwordx4 v[84:87], v4, s[32:35], s72 offen nt
    s_add_u32 s72, s72, 1024
    v_dot2_f32_bf16 v14, v88, v8, 0
    v_dot2_f32_bf16 v14, v89, v9, v14
    v_dot2_f32_bf16 v14, v90, v10, v14
    v_dot2_f32_bf16 v14, v91, v11, v14
    s_waitcnt vmcnt(3)
    buffer_load_dwordx4 v[88:91], v4, s[32:35], s72 offen nt
    s_add_u32 s72, s72, 1024
    v_dot2_f32_bf16 v15, v92, v8, 0
    v_dot2_f32_bf16 v15, v93, v9, v15
    v_dot2_f32_bf16 v15, v94, v10, v15
    v_dot2_f32_bf16 v15, v95, v11, v15
    s_waitcnt vmcnt(3)
    buffer_load_dwordx4 v[92:95], v4, s[32:35], s72 offen nt
    s_add_u32 s72, s72, 3666944
    v_add_f32_dpp v16, v12, v12 row_ror:8 row_mask:0xf bank_mask:0x3
    v_add_f32_dpp v17, v14, v14 row_ror:8 row_mask:0xf bank_mask:0x3
    s_nop 0
    v_add_f32_dpp v16, v13, v13 row_ror:8 row_mask:0xf bank_mask:0xc
    v_add_f32_dpp v17, v15, v15 row_ror:8 row_mask:0xf bank_mask:0xc
    s_nop 0
    v_add_f32_dpp v23, v16, v16 row_shl:4 row_mask:0xf bank_mask:0x5
    s_nop 1
    v_add_f32_dpp v23, v17, v17 row_shr:4 row_mask:0xf bank_mask:0xa
    v_add_f32_dpp v20, v20, v20 quad_perm:[2,3,0,1] row_mask:0xf bank_mask:0xf
    v_add_f32_dpp v21, v21, v21 quad_perm:[2,3,0,1] row_mask:0xf bank_mask:0xf
    v_add_f32_dpp v22, v22, v22 quad_perm:[2,3,0,1] row_mask:0xf bank_mask:0xf
    v_add_f32_dpp v23, v23, v23 quad_perm:[2,3,0,1] row_mask:0xf bank_mask:0xf
    v_cndmask_b32 v20, v20, v21, s[80:81]
    v_cndmask_b32 v22, v22, v23, s[80:81]
    s_nop 0
    v_add_f32_dpp v20, v20, v20 quad_perm:[1,0,3,2] row_mask:0xf bank_mask:0xf
    v_add_f32_dpp v22, v22, v22 quad_perm:[1,0,3,2] row_mask:0xf bank_mask:0xf
    v_cndmask_b32 v18, v20, v22, s[82:83]
    v_cvt_pk_bf16_f32 v18, v18, v18
    v_and_b32 v18, 0xffff0000, v18
    v_mul_f32 v18, s76, v18
    v_cvt_pk_bf16_f32 v18, v18, v18
    v_and_b32 v18, 0xffff0000, v18
    v_max_f32 v126, v126, v18
    ds_write_b32 v224, v18
    v_add_u32 v224, 256, v224
    s_nop 2
    s_branch L_v1_end
L_v1_1:
    v_dot2_f32_bf16 v12, v32, v8, 0
    v_dot2_f32_bf16 v12, v33, v9, v12
    v_dot2_f32_bf16 v12, v34, v10, v12
    v_dot2_f32_bf16 v12, v35, v11, v12
    s_waitcnt vmcnt(4)
    buffer_load_dwordx4 v[32:35], v4, s[32:35], s72 offen nt
    s_add_u32 s72, s72, 1024
    v_dot2_f32_bf16 v13, v36, v8, 0
    v_dot2_f32_bf16 v13, v37, v9, v13
    v_dot2_f32_bf16 v13, v38, v10, v13
    v_dot2_f32_bf16 v13, v39, v11, v13
    s_waitcnt vmcnt(4)
    buffer_load_dwordx4 v[36:39], v4, s[32:35], s72 offen nt
    s_add_u32 s72, s72, 1024
    v_dot2_f32_bf16 v14, v40, v8, 0
    v_dot2_f32_bf16 v14, v41, v9, v14
    v_dot2_f32_bf16 v14, v42, v10, v14
    v_dot2_f32_bf16 v14, v43, v11, v14
    s_waitcnt vmcnt(4)
    buffer_load_dwordx4 v[40:43], v4, s[32:35], s72 offen nt
    s_add_u32 s72, s72, 1024
    v_dot2_f32_bf16 v15, v44, v8, 0
    v_dot2_f32_bf16 v15, v45, v9, v15
    v_dot2_f32_bf16 v15, v46, v10, v15
    v_dot2_f32_bf16 v15, v47, v11, v15
    s_waitcnt vmcnt(4)
    buffer_load_dwordx4 v[44:47], v4, s[32:35], s72 offen nt
    s_add_u32 s72, s72, 521216
    v_add_f32_dpp v16, v12, v12 row_ror:8 row_mask:0xf bank_mask:0x3
    v_add_f32_dpp v17, v14, v14 row_ror:8 row_mask:0xf bank_mask:0x3
    s_nop 0
    v_add_f32_dpp v16, v13, v13 row_ror:8 row_mask:0xf bank_mask:0xc
    v_add_f32_dpp v17, v15, v15 row_ror:8 row_mask:0xf bank_mask:0xc
    s_nop 0
    v_add_f32_dpp v20, v16, v16 row_shl:4 row_mask:0xf bank_mask:0x5
    s_nop 1
    v_add_f32_dpp v20, v17, v17 row_shr:4 row_mask:0xf bank_mask:0xa
    v_dot2_f32_bf16 v12, v48, v8, 0
    v_dot2_f32_bf16 v12, v49, v9, v12
    v_dot2_f32_bf16 v12, v50, v10, v12
    v_dot2_f32_bf16 v12, v51, v11, v12
    s_waitcnt vmcnt(4)
    buffer_load_dwordx4 v[48:51], v4, s[32:35], s72 offen nt
    s_add_u32 s72, s72, 1024
    v_dot2_f32_bf16 v13, v52, v8, 0
    v_dot2_f32_bf16 v13, v53, v9, v13
    v_dot2_f32_bf16 v13, v54, v10, v13
    v_dot2_f32_bf16 v13, v55, v11, v13
    s_waitcnt vmcnt(4)
    buffer_load_dwordx4 v[52:55], v4, s[32:35], s72 offen nt
    s_add_u32 s72, s72, 1024
    v_dot2_f32_bf16 v14, v56, v8, 0
    v_dot2_f32_bf16 v14, v57, v9, v14
    v_dot2_f32_bf16 v14, v58, v10, v14
    v_dot2_f32_bf16 v14, v59, v11, v14
    s_waitcnt vmcnt(4)
    buffer_load_dwordx4 v[56:59], v4, s[32:35], s72 offen nt
    s_add_u32 s72, s72, 1024
    s_memrealtime s[64:65]
    ds_read_b64 v[242:243], v247 offset:46416
    v_dot2_f32_bf16 v15, v60, v8, 0
    v_dot2_f32_bf16 v15, v61, v9, v15
    v_dot2_f32_bf16 v15, v62, v10, v15
    v_dot2_f32_bf16 v15, v63, v11, v15
    s_waitcnt vmcnt(4)
    buffer_load_dwordx4 v[60:63], v4, s[32:35], s72 offen nt
    s_add_u32 s72, s72, 3666944
    v_add_f32_dpp v16, v12, v12 row_ror:8 row_mask:0xf bank_mask:0x3
    v_add_f32_dpp v17, v14, v14 row_ror:8 row_mask:0xf bank_mask:0x3
    s_nop 0
    v_add_f32_dpp v16, v13, v13 row_ror:8 row_mask:0xf bank_mask:0xc
    v_add_f32_dpp v17, v15, v15 row_ror:8 row_mask:0xf bank_mask:0xc
    s_nop 0
    v_add_f32_dpp v21, v16, v16 row_shl:4 row_mask:0xf bank_mask:0x5
    s_nop 1
    v_add_f32_dpp v21, v17, v17 row_shr:4 row_mask:0xf bank_mask:0xa
    v_dot2_f32_bf16 v12, v64, v8, 0
    v_dot2_f32_bf16 v12, v65, v9, v12
    v_dot2_f32_bf16 v12, v66, v10, v12
    v_dot2_f32_bf16 v12, v67, v11, v12
    s_waitcnt vmcnt(4)
    buffer_load_dwordx4 v[64:67], v4, s[32:35], s72 offen nt
    s_add_u32 s72, s72, 1024
    v_dot2_f32_bf16 v13, v68, v8, 0
    v_dot2_f32_bf16 v13, v69, v9, v13
    v_dot2_f32_bf16 v13, v70, v10, v13
    v_dot2_f32_bf16 v13, v71, v11, v13
    s_waitcnt vmcnt(4)
    buffer_load_dwordx4 v[68:71], v4, s[32:35], s72 offen nt
    s_add_u32 s72, s72, 1024
    v_dot2_f32_bf16 v14, v72, v8, 0
    v_dot2_f32_bf16 v14, v73, v9, v14
    v_dot2_f32_bf16 v14, v74, v10, v14
    v_dot2_f32_bf16 v14, v75, v11, v14
    s_waitcnt vmcnt(4)
    buffer_load_dwordx4 v[72:75], v4, s[32:35], s72 offen nt
    s_add_u32 s72, s72, 1024
    v_dot2_f32_bf16 v15, v76, v8, 0
    v_dot2_f32_bf16 v15, v77, v9, v15
    v_dot2_f32_bf16 v15, v78, v10, v15
    v_dot2_f32_bf16 v15, v79, v11, v15
    s_waitcnt vmcnt(4)
    buffer_load_dwordx4 v[76:79], v4, s[32:35], s72 offen nt
    s_add_u32 s72, s72, 521216
    v_add_f32_dpp v16, v12, v12 row_ror:8 row_mask:0xf bank_mask:0x3
    v_add_f32_dpp v17, v14, v14 row_ror:8 row_mask:0xf bank_mask:0x3
    s_nop 0
    v_add_f32_dpp v16, v13, v13 row_ror:8 row_mask:0xf bank_mask:0xc
    v_add_f32_dpp v17, v15, v15 row_ror:8 row_mask:0xf bank_mask:0xc
    s_nop 0
    v_add_f32_dpp v22, v16, v16 row_shl:4 row_mask:0xf bank_mask:0x5
    s_nop 1
    v_add_f32_dpp v22, v17, v17 row_shr:4 row_mask:0xf bank_mask:0xa
    s_waitcnt lgkmcnt(0)
    v_readfirstlane_b32 s62, v242
    v_readfirstlane_b32 s63, v243
    s_sub_u32 s68, s64, s69
    s_add_u32 s69, s69, 216
    s_add_u32 s67, s67, 1
    v_mov_b32 v244, s68
    v_mov_b32 v245, s67
    ds_write_b64 v246, v[244:245] offset:46432
    s_sub_u32 s68, s68, s62
    s_and_b32 s68, s68, s63
    s_mov_b32 s70, 0
    s_cmp_gt_i32 s68, -60
    s_addc_u32 s70, s70, 0
    s_cmp_gt_i32 s68, 25
    s_addc_u32 s70, s70, 0
    s_cmp_gt_i32 s68, 90
    s_addc_u32 s70, s70, 0
    v_dot2_f32_bf16 v12, v80, v8, 0
    v_dot2_f32_bf16 v12, v81, v9, v12
    v_dot2_f32_bf16 v12, v82, v10, v12
    v_dot2_f32_bf16 v12, v83, v11, v12
    s_waitcnt vmcnt(4)
    buffer_load_dwordx4 v[80:83], v4, s[32:35], s72 offen nt
    s_add_u32 s72, s72, 1024
    v_dot2_f32_bf16 v13, v84, v8, 0
    v_dot2_f32_bf16 v13, v85, v9, v13
    v_dot2_f32_bf16 v13, v86, v10, v13
    v_dot2_f32_bf16 v13, v87, v11, v13
    s_waitcnt vmcnt(4)
    buffer_load_dwordx4 v[84:87], v4, s[32:35], s72 offen nt
    s_add_u32 s72, s72, 1024
    v_dot2_f32_bf16 v14, v88, v8, 0
    v_dot2_f32_bf16 v14, v89, v9, v14
    v_dot2_f32_bf16 v14, v90, v10, v14
    v_dot2_f32_bf16 v14, v91, v11, v14
    s_waitcnt vmcnt(4)
    buffer_load_dwordx4 v[88:91], v4, s[32:35], s72 offen nt
    s_add_u32 s72, s72, 1024
    v_dot2_f32_bf16 v15, v92, v8, 0
    v_dot2_f32_bf16 v15, v93, v9, v15
    v_dot2_f32_bf16 v15, v94, v10, v15
    v_dot2_f32_bf16 v15, v95, v11, v15
    s_waitcnt vmcnt(4)
    buffer_load_dwordx4 v[92:95], v4, s[32:35], s72 offen nt
    s_add_u32 s72, s72, 3666944
    v_add_f32_dpp v16, v12, v12 row_ror:8 row_mask:0xf bank_mask:0x3
    v_add_f32_dpp v17, v14, v14 row_ror:8 row_mask:0xf bank_mask:0x3
    s_nop 0
    v_add_f32_dpp v16, v13, v13 row_ror:8 row_mask:0xf bank_mask:0xc
    v_add_f32_dpp v17, v15, v15 row_ror:8 row_mask:0xf bank_mask:0xc
    s_nop 0
    v_add_f32_dpp v23, v16, v16 row_shl:4 row_mask:0xf bank_mask:0x5
    s_nop 1
    v_add_f32_dpp v23, v17, v17 row_shr:4 row_mask:0xf bank_mask:0xa
    v_add_f32_dpp v20, v20, v20 quad_perm:[2,3,0,1] row_mask:0xf bank_mask:0xf
    v_add_f32_dpp v21, v21, v21 quad_perm:[2,3,0,1] row_mask:0xf bank_mask:0xf
    v_add_f32_dpp v22, v22, v22 quad_perm:[2,3,0,1] row_mask:0xf bank_mask:0xf
    v_add_f32_dpp v23, v23, v23 quad_perm:[2,3,0,1] row_mask:0xf bank_mask:0xf
    v_cndmask_b32 v20, v20, v21, s[80:81]
    v_cndmask_b32 v22, v22, v23, s[80:81]
    s_nop 0
    v_add_f32_dpp v20, v20, v20 quad_perm:[1,0,3,2] row_mask:0xf bank_mask:0xf
    v_add_f32_dpp v22, v22, v22 quad_perm:[1,0,3,2] row_mask:0xf bank_mask:0xf
    v_cndmask_b32 v18, v20, v22, s[82:83]
    v_cvt_pk_bf16_f32 v18, v18, v18
    v_and_b32 v18, 0xffff0000, v18
    v_mul_f32 v18, s76, v18
    v_cvt_pk_bf16_f32 v18, v18, v18
    v_and_b32 v18, 0xffff0000, v18
    v_max_f32 v126, v126, v18
    ds_write_b32 v224, v18
    v_add_u32 v224, 256, v224
    s_nop 2
    s_branch L_v1_end
L_v1_2:
    v_dot2_f32_bf16 v12, v32, v8, 0
    v_dot2_f32_bf16 v12, v33, v9, v12
    v_dot2_f32_bf16 v12, v34, v10, v12
    v_dot2_f32_bf16 v12, v35, v11, v12
    s_waitcnt vmcnt(5)
    buffer_load_dwordx4 v[32:35], v4, s[32:35], s72 offen nt
    s_add_u32 s72, s72, 1024
    v_dot2_f32_bf16 v13, v36, v8, 0
    v_dot2_f32_bf16 v13, v37, v9, v13
    v_dot2_f32_bf16 v13, v38, v10, v13
    v_dot2_f32_bf16 v13, v39, v11, v13
    s_waitcnt vmcnt(5)
    buffer_load_dwordx4 v[36:39], v4, s[32:35], s72 offen nt
    s_add_u32 s72, s72, 1024
    v_dot2_f32_bf16 v14, v40, v8, 0
    v_dot2_f32_bf16 v14, v41, v9, v14
    v_dot2_f32_bf16 v14, v42, v10, v14
    v_dot2_f32_bf16 v14, v43, v11, v14
    s_waitcnt vmcnt(5)
    buffer_load_dwordx4 v[40:43], v4, s[32:35], s72 offen nt
    s_add_u32 s72, s72, 1024
    v_dot2_f32_bf16 v15, v44, v8, 0
    v_dot2_f32_bf16 v15, v45, v9, v15
    v_dot2_f32_bf16 v15, v46, v10, v15
    v_dot2_f32_bf16 v15, v47, v11, v15
    s_waitcnt vmcnt(5)
    buffer_load_dwordx4 v[44:47], v4, s[32:35], s72 offen nt
    s_add_u32 s72, s72, 521216
    v_add_f32_dpp v16, v12, v12 row_ror:8 row_mask:0xf bank_mask:0x3
    v_add_f32_dpp v17, v14, v14 row_ror:8 row_mask:0xf bank_mask:0x3
    s_nop 0
    v_add_f32_dpp v16, v13, v13 row_ror:8 row_mask:0xf bank_mask:0xc
    v_add_f32_dpp v17, v15, v15 row_ror:8 row_mask:0xf bank_mask:0xc
    s_nop 0
    v_add_f32_dpp v20, v16, v16 row_shl:4 row_mask:0xf bank_mask:0x5
    s_nop 1
    v_add_f32_dpp v20, v17, v17 row_shr:4 row_mask:0xf bank_mask:0xa
    v_dot2_f32_bf16 v12, v48, v8, 0
    v_dot2_f32_bf16 v12, v49, v9, v12
    v_dot2_f32_bf16 v12, v50, v10, v12
    v_dot2_f32_bf16 v12, v51, v11, v12
    s_waitcnt vmcnt(5)
    buffer_load_dwordx4 v[48:51], v4, s[32:35], s72 offen nt
    s_add_u32 s72, s72, 1024
    v_dot2_f32_bf16 v13, v52, v8, 0
    v_dot2_f32_bf16 v13, v53, v9, v13
    v_dot2_f32_bf16 v13, v54, v10, v13
    v_dot2_f32_bf16 v13, v55, v11, v13
    s_waitcnt vmcnt(5)
    buffer_load_dwordx4 v[52:55], v4, s[32:35], s72 offen nt
    s_add_u32 s72, s72, 1024
    v_dot2_f32_bf16 v14, v56, v8, 0
    v_dot2_f32_bf16 v14, v57, v9, v14
    v_dot2_f32_bf16 v14, v58, v10, v14
    v_dot2_f32_bf16 v14, v59, v11, v14
    s_waitcnt vmcnt(5)
    buffer_load_dwordx4 v[56:59], v4, s[32:35], s72 offen nt
    s_add_u32 s72, s72, 1024
    s_memrealtime s[64:65]
    ds_read_b64 v[242:243], v247 offset:46416
    v_dot2_f32_bf16 v15, v60, v8, 0
    v_dot2_f32_bf16 v15, v61, v9, v15
    v_dot2_f32_bf16 v15, v62, v10, v15
    v_dot2_f32_bf16 v15, v63, v11, v15
    s_waitcnt vmcnt(5)
    buffer_load_dwordx4 v[60:63], v4, s[32:35], s72 offen nt
    s_add_u32 s72, s72, 3666944
    v_add_f32_dpp v16, v12, v12 row_ror:8 row_mask:0xf bank_mask:0x3
    v_add_f32_dpp v17, v14, v14 row_ror:8 row_mask:0xf bank_mask:0x3
    s_nop 0
    v_add_f32_dpp v16, v13, v13 row_ror:8 row_mask:0xf bank_mask:0xc
    v_add_f32_dpp v17, v15, v15 row_ror:8 row_mask:0xf bank_mask:0xc
    s_nop 0
    v_add_f32_dpp v21, v16, v16 row_shl:4 row_mask:0xf bank_mask:0x5
    s_nop 1
    v_add_f32_dpp v21, v17, v17 row_shr:4 row_mask:0xf bank_mask:0xa
    v_dot2_f32_bf16 v12, v64, v8, 0
    v_dot2_f32_bf16 v12, v65, v9, v12
    v_dot2_f32_bf16 v12, v66, v10, v12
    v_dot2_f32_bf16 v12, v67, v11, v12
    s_waitcnt vmcnt(5)
    buffer_load_dwordx4 v[64:67], v4, s[32:35], s72 offen nt
    s_add_u32 s72, s72, 1024
    v_dot2_f32_bf16 v13, v68, v8, 0
    v_dot2_f32_bf16 v13, v69, v9, v13
    v_dot2_f32_bf16 v13, v70, v10, v13
    v_dot2_f32_bf16 v13, v71, v11, v13
    s_waitcnt vmcnt(5)
    buffer_load_dwordx4 v[68:71], v4, s[32:35], s72 offen nt
    s_add_u32 s72, s72, 1024
    v_dot2_f32_bf16 v14, v72, v8, 0
    v_dot2_f32_bf16 v14, v73, v9, v14
    v_dot2_f32_bf16 v14, v74, v10, v14
    v_dot2_f32_bf16 v14, v75, v11, v14
    s_waitcnt vmcnt(5)
    buffer_load_dwordx4 v[72:75], v4, s[32:35], s72 offen nt
    s_add_u32 s72, s72, 1024
    v_dot2_f32_bf16 v15, v76, v8, 0
    v_dot2_f32_bf16 v15, v77, v9, v15
    v_dot2_f32_bf16 v15, v78, v10, v15
    v_dot2_f32_bf16 v15, v79, v11, v15
    s_waitcnt vmcnt(5)
    buffer_load_dwordx4 v[76:79], v4, s[32:35], s72 offen nt
    s_add_u32 s72, s72, 521216
    v_add_f32_dpp v16, v12, v12 row_ror:8 row_mask:0xf bank_mask:0x3
    v_add_f32_dpp v17, v14, v14 row_ror:8 row_mask:0xf bank_mask:0x3
    s_nop 0
    v_add_f32_dpp v16, v13, v13 row_ror:8 row_mask:0xf bank_mask:0xc
    v_add_f32_dpp v17, v15, v15 row_ror:8 row_mask:0xf bank_mask:0xc
    s_nop 0
    v_add_f32_dpp v22, v16, v16 row_shl:4 row_mask:0xf bank_mask:0x5
    s_nop 1
    v_add_f32_dpp v22, v17, v17 row_shr:4 row_mask:0xf bank_mask:0xa
    s_waitcnt lgkmcnt(0)
    v_readfirstlane_b32 s62, v242
    v_readfirstlane_b32 s63, v243
    s_sub_u32 s68, s64, s69
    s_add_u32 s69, s69, 216
    s_add_u32 s67, s67, 1
    v_mov_b32 v244, s68
    v_mov_b32 v245, s67
    ds_write_b64 v246, v[244:245] offset:46432
    s_sub_u32 s68, s68, s62
    s_and_b32 s68, s68, s63
    s_mov_b32 s70, 0
    s_cmp_gt_i32 s68, -60
    s_addc_u32 s70, s70, 0
    s_cmp_gt_i32 s68, 25
    s_addc_u32 s70, s70, 0
    s_cmp_gt_i32 s68, 90
    s_addc_u32 s70, s70, 0
    v_dot2_f32_bf16 v12, v80, v8, 0
    v_dot2_f32_bf16 v12, v81, v9, v12
    v_dot2_f32_bf16 v12, v82, v10, v12
    v_dot2_f32_bf16 v12, v83, v11, v12
    s_waitcnt vmcnt(5)
    buffer_load_dwordx4 v[80:83], v4, s[32:35], s72 offen nt
    s_add_u32 s72, s72, 1024
    v_dot2_f32_bf16 v13, v84, v8, 0
    v_dot2_f32_bf16 v13, v85, v9, v13
    v_dot2_f32_bf16 v13, v86, v10, v13
    v_dot2_f32_bf16 v13, v87, v11, v13
    s_waitcnt vmcnt(5)
    buffer_load_dwordx4 v[84:87], v4, s[32:35], s72 offen nt
    s_add_u32 s72, s72, 1024
    v_dot2_f32_bf16 v14, v88, v8, 0
    v_dot2_f32_bf16 v14, v89, v9, v14
    v_dot2_f32_bf16 v14, v90, v10, v14
    v_dot2_f32_bf16 v14, v91, v11, v14
    s_waitcnt vmcnt(5)
    buffer_load_dwordx4 v[88:91], v4, s[32:35], s72 offen nt
    s_add_u32 s72, s72, 1024
    v_dot2_f32_bf16 v15, v92, v8, 0
    v_dot2_f32_bf16 v15, v93, v9, v15
    v_dot2_f32_bf16 v15, v94, v10, v15
    v_dot2_f32_bf16 v15, v95, v11, v15
    s_waitcnt vmcnt(5)
    buffer_load_dwordx4 v[92:95], v4, s[32:35], s72 offen nt
    s_add_u32 s72, s72, 3666944
    v_add_f32_dpp v16, v12, v12 row_ror:8 row_mask:0xf bank_mask:0x3
    v_add_f32_dpp v17, v14, v14 row_ror:8 row_mask:0xf bank_mask:0x3
    s_nop 0
    v_add_f32_dpp v16, v13, v13 row_ror:8 row_mask:0xf bank_mask:0xc
    v_add_f32_dpp v17, v15, v15 row_ror:8 row_mask:0xf bank_mask:0xc
    s_nop 0
    v_add_f32_dpp v23, v16, v16 row_shl:4 row_mask:0xf bank_mask:0x5
    s_nop 1
    v_add_f32_dpp v23, v17, v17 row_shr:4 row_mask:0xf bank_mask:0xa
    v_add_f32_dpp v20, v20, v20 quad_perm:[2,3,0,1] row_mask:0xf bank_mask:0xf
    v_add_f32_dpp v21, v21, v21 quad_perm:[2,3,0,1] row_mask:0xf bank_mask:0xf
    v_add_f32_dpp v22, v22, v22 quad_perm:[2,3,0,1] row_mask:0xf bank_mask:0xf
    v_add_f32_dpp v23, v23, v23 quad_perm:[2,3,0,1] row_mask:0xf bank_mask:0xf
    v_cndmask_b32 v20, v20, v21, s[80:81]
    v_cndmask_b32 v22, v22, v23, s[80:81]
    s_nop 0
    v_add_f32_dpp v20, v20, v20 quad_perm:[1,0,3,2] row_mask:0xf bank_mask:0xf
    v_add_f32_dpp v22, v22, v22 quad_perm:[1,0,3,2] row_mask:0xf bank_mask:0xf
    v_cndmask_b32 v18, v20, v22, s[82:83]
    v_cvt_pk_bf16_f32 v18, v18, v18
    v_and_b32 v18, 0xffff0000, v18
    v_mul_f32 v18, s76, v18
    v_cvt_pk_bf16_f32 v18, v18, v18
    v_and_b32 v18, 0xffff0000, v18
    v_max_f32 v126, v126, v18
    ds_write_b32 v224, v18
    v_add_u32 v224, 256, v224
    s_nop 2
    s_branch L_v1_end
L_v1_3:
    v_dot2_f32_bf16 v12, v32, v8, 0
    v_dot2_f32_bf16 v12, v33, v9, v12
    v_dot2_f32_bf16 v12, v34, v10, v12
    v_dot2_f32_bf16 v12, v35, v11, v12
    s_waitcnt vmcnt(6)
    buffer_load_dwordx4 v[32:35], v4, s[32:35], s72 offen nt
    s_add_u32 s72, s72, 1024
    v_dot2_f32_bf16 v13, v36, v8, 0
    v_dot2_f32_bf16 v13, v37, v9, v13
    v_dot2_f32_bf16 v13, v38, v10, v13
    v_dot2_f32_bf16 v13, v39, v11, v13
    s_waitcnt vmcnt(6)
    buffer_load_dwordx4 v[36:39], v4, s[32:35], s72 offen nt
    s_add_u32 s72, s72, 1024
    v_dot2_f32_bf16 v14, v40, v8, 0
    v_dot2_f32_bf16 v14, v41, v9, v14
    v_dot2_f32_bf16 v14, v42, v10, v14
    v_dot2_f32_bf16 v14, v43, v11, v14
    s_waitcnt vmcnt(6)
    buffer_load_dwordx4 v[40:43], v4, s[32:35], s72 offen nt
    s_add_u32 s72, s72, 1024
    v_dot2_f32_bf16 v15, v44, v8, 0
    v_dot2_f32_bf16 v15, v45, v9, v15
    v_dot2_f32_bf16 v15, v46, v10, v15
    v_dot2_f32_bf16 v15, v47, v11, v15
    s_waitcnt vmcnt(6)
    buffer_load_dwordx4 v[44:47], v4, s[32:35], s72 offen nt
    s_add_u32 s72, s72, 521216
    v_add_f32_dpp v16, v12, v12 row_ror:8 row_mask:0xf bank_mask:0x3
    v_add_f32_dpp v17, v14, v14 row_ror:8 row_mask:0xf bank_mask:0x3
    s_nop 0
    v_add_f32_dpp v16, v13, v13 row_ror:8 row_mask:0xf bank_mask:0xc
    v_add_f32_dpp v17, v15, v15 row_ror:8 row_mask:0xf bank_mask:0xc
    s_nop 0
    v_add_f32_dpp v20, v16, v16 row_shl:4 row_mask:0xf bank_mask:0x5
    s_nop 1
    v_add_f32_dpp v20, v17, v17 row_shr:4 row_mask:0xf bank_mask:0xa
    v_dot2_f32_bf16 v12, v48, v8, 0
    v_dot2_f32_bf16 v12, v49, v9, v12
    v_dot2_f32_bf16 v12, v50, v10, v12
    v_dot2_f32_bf16 v12, v51, v11, v12
    s_waitcnt vmcnt(6)
    buffer_load_dwordx4 v[48:51], v4, s[32:35], s72 offen nt
    s_add_u32 s72, s72, 1024
    v_dot2_f32_bf16 v13, v52, v8, 0
    v_dot2_f32_bf16 v13, v53, v9, v13
    v_dot2_f32_bf16 v13, v54, v10, v13
    v_dot2_f32_bf16 v13, v55, v11, v13
    s_waitcnt vmcnt(6)
    buffer_load_dwordx4 v[52:55], v4, s[32:35], s72 offen nt
    s_add_u32 s72, s72, 1024
    v_dot2_f32_bf16 v14, v56, v8, 0
    v_dot2_f32_bf16 v14, v57, v9, v14
    v_dot2_f32_bf16 v14, v58, v10, v14
    v_dot2_f32_bf16 v14, v59, v11, v14
    s_waitcnt vmcnt(6)
    buffer_load_dwordx4 v[56:59], v4, s[32:35], s72 offen nt
    s_add_u32 s72, s72, 1024
    s_memrealtime s[64:65]
    ds_read_b64 v[242:243], v247 offset:46416
    v_dot2_f32_bf16 v15, v60, v8, 0
    v_dot2_f32_bf16 v15, v61, v9, v15
    v_dot2_f32_bf16 v15, v62, v10, v15
    v_dot2_f32_bf16 v15, v63, v11, v15
    s_waitcnt vmcnt(6)
    buffer_load_dwordx4 v[60:63], v4, s[32:35], s72 offen nt
    s_add_u32 s72, s72, 3666944
    v_add_f32_dpp v16, v12, v12 row_ror:8 row_mask:0xf bank_mask:0x3
    v_add_f32_dpp v17, v14, v14 row_ror:8 row_mask:0xf bank_mask:0x3
    s_nop 0
    v_add_f32_dpp v16, v13, v13 row_ror:8 row_mask:0xf bank_mask:0xc
    v_add_f32_dpp v17, v15, v15 row_ror:8 row_mask:0xf bank_mask:0xc
    s_nop 0
    v_add_f32_dpp v21, v16, v16 row_shl:4 row_mask:0xf bank_mask:0x5
    s_nop 1
    v_add_f32_dpp v21, v17, v17 row_shr:4 row_mask:0xf bank_mask:0xa
    v_dot2_f32_bf16 v12, v64, v8, 0
    v_dot2_f32_bf16 v12, v65, v9, v12
    v_dot2_f32_bf16 v12, v66, v10, v12
    v_dot2_f32_bf16 v12, v67, v11, v12
    s_waitcnt vmcnt(6)
    buffer_load_dwordx4 v[64:67], v4, s[32:35], s72 offen nt
    s_add_u32 s72, s72, 1024
    v_dot2_f32_bf16 v13, v68, v8, 0
    v_dot2_f32_bf16 v13, v69, v9, v13
    v_dot2_f32_bf16 v13, v70, v10, v13
    v_dot2_f32_bf16 v13, v71, v11, v13
    s_waitcnt vmcnt(6)
    buffer_load_dwordx4 v[68:71], v4, s[32:35], s72 offen nt
    s_add_u32 s72, s72, 1024
    v_dot2_f32_bf16 v14, v72, v8, 0
    v_dot2_f32_bf16 v14, v73, v9, v14
    v_dot2_f32_bf16 v14, v74, v10, v14
    v_dot2_f32_bf16 v14, v75, v11, v14
    s_waitcnt vmcnt(6)
    buffer_load_dwordx4 v[72:75], v4, s[32:35], s72 offen nt
    s_add_u32 s72, s72, 1024
    v_dot2_f32_bf16 v15, v76, v8, 0
    v_dot2_f32_bf16 v15, v77, v9, v15
    v_dot2_f32_bf16 v15, v78, v10, v15
    v_dot2_f32_bf16 v15, v79, v11, v15
    s_waitcnt vmcnt(6)
    buffer_load_dwordx4 v[76:79], v4, s[32:35], s72 offen nt
    s_add_u32 s72, s72, 521216
    v_add_f32_dpp v16, v12, v12 row_ror:8 row_mask:0xf bank_mask:0x3
    v_add_f32_dpp v17, v14, v14 row_ror:8 row_mask:0xf bank_mask:0x3
    s_nop 0
    v_add_f32_dpp v16, v13, v13 row_ror:8 row_mask:0xf bank_mask:0xc
    v_add_f32_dpp v17, v15, v15 row_ror:8 row_mask:0xf bank_mask:0xc
    s_nop 0
    v_add_f32_dpp v22, v16, v16 row_shl:4 row_mask:0xf bank_mask:0x5
    s_nop 1
    v_add_f32_dpp v22, v17, v17 row_shr:4 row_mask:0xf bank_mask:0xa
    s_waitcnt lgkmcnt(0)
    v_readfirstlane_b32 s62, v242
    v_readfirstlane_b32 s63, v243
    s_sub_u32 s68, s64, s69
    s_add_u32 s69, s69, 216
    s_add_u32 s67, s67, 1
    v_mov_b32 v244, s68
    v_mov_b32 v245, s67
    ds_write_b64 v246, v[244:245] offset:46432
    s_sub_u32 s68, s68, s62
    s_and_b32 s68, s68, s63
    s_mov_b32 s70, 0
    s_cmp_gt_i32 s68, -60
    s_addc_u32 s70, s70, 0
    s_cmp_gt_i32 s68, 25
    s_addc_u32 s70, s70, 0
    s_cmp_gt_i32 s68, 90
    s_addc_u32 s70, s70, 0
    v_dot2_f32_bf16 v12, v80, v8, 0
    v_dot2_f32_bf16 v12, v81, v9, v12
    v_dot2_f32_bf16 v12, v82, v10, v12
    v_dot2_f32_bf16 v12, v83, v11, v12
    s_waitcnt vmcnt(6)
    buffer_load_dwordx4 v[80:83], v4, s[32:35], s72 offen nt
    s_add_u32 s72, s72, 1024
    v_dot2_f32_bf16 v13, v84, v8, 0
    v_dot2_f32_bf16 v13, v85, v9, v13
    v_dot2_f32_bf16 v13, v86, v10, v13
    v_dot2_f32_bf16 v13, v87, v11, v13
    s_waitcnt vmcnt(6)
    buffer_load_dwordx4 v[84:87], v4, s[32:35], s72 offen nt
    s_add_u32 s72, s72, 1024
    v_dot2_f32_bf16 v14, v88, v8, 0
    v_dot2_f32_bf16 v14, v89, v9, v14
    v_dot2_f32_bf16 v14, v90, v10, v14
    v_dot2_f32_bf16 v14, v91, v11, v14
    s_waitcnt vmcnt(6)
    buffer_load_dwordx4 v[88:91], v4, s[32:35], s72 offen nt
    s_add_u32 s72, s72, 1024
    v_dot2_f32_bf16 v15, v92, v8, 0
    v_dot2_f32_bf16 v15, v93, v9, v15
    v_dot2_f32_bf16 v15, v94, v10, v15
    v_dot2_f32_bf16 v15, v95, v11, v15
    s_waitcnt vmcnt(6)
    buffer_load_dwordx4 v[92:95], v4, s[32:35], s72 offen nt
    s_add_u32 s72, s72, 3666944
    v_add_f32_dpp v16, v12, v12 row_ror:8 row_mask:0xf bank_mask:0x3
    v_add_f32_dpp v17, v14, v14 row_ror:8 row_mask:0xf bank_mask:0x3
    s_nop 0
    v_add_f32_dpp v16, v13, v13 row_ror:8 row_mask:0xf bank_mask:0xc
    v_add_f32_dpp v17, v15, v15 row_ror:8 row_mask:0xf bank_mask:0xc
    s_nop 0
    v_add_f32_dpp v23, v16, v16 row_shl:4 row_mask:0xf bank_mask:0x5
    s_nop 1
    v_add_f32_dpp v23, v17, v17 row_shr:4 row_mask:0xf bank_mask:0xa
    v_add_f32_dpp v20, v20, v20 quad_perm:[2,3,0,1] row_mask:0xf bank_mask:0xf
    v_add_f32_dpp v21, v21, v21 quad_perm:[2,3,0,1] row_mask:0xf bank_mask:0xf
    v_add_f32_dpp v22, v22, v22 quad_perm:[2,3,0,1] row_mask:0xf bank_mask:0xf
    v_add_f32_dpp v23, v23, v23 quad_perm:[2,3,0,1] row_mask:0xf bank_mask:0xf
    v_cndmask_b32 v20, v20, v21, s[80:81]
    v_cndmask_b32 v22, v22, v23, s[80:81]
    s_nop 0
    v_add_f32_dpp v20, v20, v20 quad_perm:[1,0,3,2] row_mask:0xf bank_mask:0xf
    v_add_f32_dpp v22, v22, v22 quad_perm:[1,0,3,2] row_mask:0xf bank_mask:0xf
    v_cndmask_b32 v18, v20, v22, s[82:83]
    v_cvt_pk_bf16_f32 v18, v18, v18
    v_and_b32 v18, 0xffff0000, v18
    v_mul_f32 v18, s76, v18
    v_cvt_pk_bf16_f32 v18, v18, v18
    v_and_b32 v18, 0xffff0000, v18
    v_max_f32 v126, v126, v18
    ds_write_b32 v224, v18
    v_add_u32 v224, 256, v224
    s_nop 2
L_v1_end:
    s_cmp_eq_u32 s70, 1
    s_cbranch_scc1 L_v2_1
    s_cmp_eq_u32 s70, 2
    s_cbranch_scc1 L_v2_2
    s_cmp_eq_u32 s70, 3
    s_cbranch_scc1 L_v2_3
    v_dot2_f32_bf16 v12, v128, v8, 0
    v_dot2_f32_bf16 v12, v129, v9, v12
    v_dot2_f32_bf16 v12, v130, v10, v12
    v_dot2_f32_bf16 v12, v131, v11, v12
    s_waitcnt vmcnt(3)
    buffer_load_dwordx4 v[128:131], v4, s[32:35], s72 offen nt
    s_add_u32 s72, s72, 1024
    v_dot2_f32_bf16 v13, v132, v8, 0
    v_dot2_f32_bf16 v13, v133, v9, v13
    v_dot2_f32_bf16 v13, v134, v10, v13
    v_dot2_f32_bf16 v13, v135, v11, v13
    s_waitcnt vmcnt(3)
    buffer_load_dwordx4 v[132:135], v4, s[32:35], s72 offen nt
    s_add_u32 s72, s72, 1024
    v_dot2_f32_bf16 v14, v136, v8, 0
    v_dot2_f32_bf16 v14, v137, v9, v14
    v_dot2_f32_bf16 v14, v138, v10, v14
    v_dot2_f32_bf16 v14, v139, v11, v14
    s_waitcnt vmcnt(3)
    buffer_load_dwordx4 v[136:139], v4, s[32:35], s72 offen nt
    s_add_u32 s72, s72, 1024
    v_dot2_f32_bf16 v15, v140, v8, 0
    v_dot2_f32_bf16 v15, v141, v9, v15
    v_dot2_f32_bf16 v15, v142, v10, v15
    v_dot2_f32_bf16 v15, v143, v11, v15
    s_waitcnt vmcnt(3)
    buffer_load_dwordx4 v[140:143], v4, s[32:35], s72 offen nt
    s_add_u32 s72, s72, 521216
    v_add_f32_dpp v16, v12, v12 row_ror:8 row_mask:0xf bank_mask:0x3
    v_add_f32_dpp v17, v14, v14 row_ror:8 row_mask:0xf bank_mask:0x3
    s_nop 0
    v_add_f32_dpp v16, v13, v13 row_ror:8 row_mask:0xf bank_mask:0xc
    v_add_f32_dpp v17, v15, v15 row_ror:8 row_mask:0xf bank_mask:0xc
    s_nop 0
    v_add_f32_dpp v20, v16, v16 row_shl:4 row_mask:0xf bank_mask:0x5
    s_nop 1
    v_add_f32_dpp v20, v17, v17 row_shr:4 row_mask:0xf bank_mask:0xa
    v_dot2_f32_bf16 v12, v144, v8, 0
    v_dot2_f32_bf16 v12, v145, v9, v12
    v_dot2_f32_bf16 v12, v146, v10, v12
    v_dot2_f32_bf16 v12, v147, v11, v12
    s_waitcnt vmcnt(3)
    buffer_load_dwordx4 v[144:147], v4, s[32:35], s72 offen nt
    s_add_u32 s72, s72, 1024
    v_dot2_f32_bf16 v13, v148, v8, 0
    v_dot2_f32_bf16 v13, v149, v9, v13
    v_dot2_f32_bf16 v13, v150, v10, v13
    v_dot2_f32_bf16 v13, v151, v11, v13
    s_waitcnt vmcnt(3)
    buffer_load_dwordx4 v[148:151], v4, s[32:35], s72 offen nt
    s_add_u32 s72, s72, 1024
    v_dot2_f32_bf16 v14, v152, v8, 0
    v_dot2_f32_bf16 v14, v153, v9, v14
    v_dot2_f32_bf16 v14, v154, v10, v14
    v_dot2_f32_bf16 v14, v155, v11, v14
    s_waitcnt vmcnt(3)
    buffer_load_dwordx4 v[152:155], v4, s[32:35], s72 offen nt
    s_add_u32 s72, s72, 1024
    s_memrealtime s[64:65]
    ds_read_b64 v[242:243], v247 offset:46416
    v_dot2_f32_bf16 v15, v156, v8, 0
    v_dot2_f32_bf16 v15, v157, v9, v15
    v_dot2_f32_bf16 v15, v158, v10, v15
    v_dot2_f32_bf16 v15, v159, v11, v15
    s_waitcnt vmcnt(3)
    buffer_load_dwordx4 v[156:159], v4, s[32:35], s72 offen nt
    s_add_u32 s72, s72, 3666944
    v_add_f32_dpp v16, v12, v12 row_ror:8 row_mask:0xf bank_mask:0x3
    v_add_f32_dpp v17, v14, v14 row_ror:8 row_mask:0xf bank_mask:0x3
    s_nop 0
    v_add_f32_dpp v16, v13, v13 row_ror:8 row_mask:0xf bank_mask:0xc
    v_add_f32_dpp v17, v15, v15 row_ror:8 row_mask:0xf bank_mask:0xc
    s_nop 0
    v_add_f32_dpp v21, v16, v16 row_shl:4 row_mask:0xf bank_mask:0x5
    s_nop 1
    v_add_f32_dpp v21, v17, v17 row_shr:4 row_mask:0xf bank_mask:0xa
    v_dot2_f32_bf16 v12, v160, v8, 0
    v_dot2_f32_bf16 v12, v161, v9, v12
    v_dot2_f32_bf16 v12, v162, v10, v12
    v_dot2_f32_bf16 v12, v163, v11, v12
    s_waitcnt vmcnt(3)
    buffer_load_dwordx4 v[160:163], v4, s[32:35], s72 offen nt
    s_add_u32 s72, s72, 1024
    v_dot2_f32_bf16 v13, v164, v8, 0
    v_dot2_f32_bf16 v13, v165, v9, v13
    v_dot2_f32_bf16 v13, v166, v10, v13
    v_dot2_f32_bf16 v13, v167, v11, v13
    s_waitcnt vmcnt(3)
    buffer_load_dwordx4 v[164:167], v4, s[32:35], s72 offen nt
    s_add_u32 s72, s72, 1024
    v_dot2_f32_bf16 v14, v168, v8, 0
    v_dot2_f32_bf16 v14, v169, v9, v14
    v_dot2_f32_bf16 v14, v170, v10, v14
    v_dot2_f32_bf16 v14, v171, v11, v14
    s_waitcnt vmcnt(3)
    buffer_load_dwordx4 v[168:171], v4, s[32:35], s72 offen nt
    s_add_u32 s72, s72, 1024
    v_dot2_f32_bf16 v15, v172, v8, 0
    v_dot2_f32_bf16 v15, v173, v9, v15
    v_dot2_f32_bf16 v15, v174, v10, v15
    v_dot2_f32_bf16 v15, v175, v11, v15
    s_waitcnt vmcnt(3)
    buffer_load_dwordx4 v[172:175], v4, s[32:35], s72 offen nt
    s_add_u32 s72, s72, 521216
    v_add_f32_dpp v16, v12, v12 row_ror:8 row_mask:0xf bank_mask:0x3
    v_add_f32_dpp v17, v14, v14 row_ror:8 row_mask:0xf bank_mask:0x3
    s_nop 0
    v_add_f32_dpp v16, v13, v13 row_ror:8 row_mask:0xf bank_mask:0xc
    v_add_f32_dpp v17, v15, v15 row_ror:8 row_mask:0xf bank_mask:0xc
    s_nop 0
    v_add_f32_dpp v22, v16, v16 row_shl:4 row_mask:0xf bank_mask:0x5
    s_nop 1
    v_add_f32_dpp v22, v17, v17 row_shr:4 row_mask:0xf bank_mask:0xa
    s_waitcnt lgkmcnt(0)
    v_readfirstlane_b32 s62, v242
    v_readfirstlane_b32 s63, v243
    s_sub_u32 s68, s64, s69
    s_add_u32 s69, s69, 216
    s_add_u32 s67, s67, 1
    v_mov_b32 v244, s68
    v_mov_b32 v245, s67
    ds_write_b64 v246, v[244:245] offset:46432
    s_sub_u32 s68, s68, s62
    s_and_b32 s68, s68, s63
    s_mov_b32 s70, 0
    s_cmp_gt_i32 s68, -60
    s_addc_u32 s70, s70, 0
    s_cmp_gt_i32 s68, 25
    s_addc_u32 s70, s70, 0
    s_cmp_gt_i32 s68, 90
    s_addc_u32 s70, s70, 0
    v_dot2_f32_bf16 v12, v176, v8, 0
    v_dot2_f32_bf16 v12, v177, v9, v12
    v_dot2_f32_bf16 v12, v178, v10, v12
    v_dot2_f32_bf16 v12, v179, v11, v12
    s_waitcnt vmcnt(3)
    buffer_load_dwordx4 v[176:179], v4, s[32:35], s72 offen nt
    s_add_u32 s72, s72, 1024
    v_dot2_f32_bf16 v13, v180, v8, 0
    v_dot2_f32_bf16 v13, v181, v9, v13
    v_dot2_f32_bf16 v13, v182, v10, v13
    v_dot2_f32_bf16 v13, v183, v11, v13
    s_waitcnt vmcnt(3)
    buffer_load_dwordx4 v[180:183], v4, s[32:35], s72 offen nt
    s_add_u32 s72, s72, 1024
    v_dot2_f32_bf16 v14, v184, v8, 0
    v_dot2_f32_bf16 v14, v185, v9, v14
    v_dot2_f32_bf16 v14, v186, v10, v14
    v_dot2_f32_bf16 v14, v187, v11, v14
    s_waitcnt vmcnt(3)
    buffer_load_dwordx4 v[184:187], v4, s[32:35], s72 offen nt
    s_add_u32 s72, s72, 1024
    v_dot2_f32_bf16 v15, v188, v8, 0
    v_dot2_f32_bf16 v15, v189, v9, v15
    v_dot2_f32_bf16 v15, v190, v10, v15
    v_dot2_f32_bf16 v15, v191, v11, v15
    s_waitcnt vmcnt(3)
    buffer_load_dwordx4 v[188:191], v4, s[32:35], s72 offen nt
    s_or_b32 s72, s72, 4291428351
    s_add_u32 s72, s72, 1
    s_and_b32 s72, s72, 3538944
    v_add_f32_dpp v16, v12, v12 row_ror:8 row_mask:0xf bank_mask:0x3
    v_add_f32_dpp v17, v14, v14 row_ror:8 row_mask:0xf bank_mask:0x3
    s_nop 0
    v_add_f32_dpp v16, v13, v13 row_ror:8 row_mask:0xf bank_mask:0xc
    v_add_f32_dpp v17, v15, v15 row_ror:8 row_mask:0xf bank_mask:0xc
    s_nop 0
    v_add_f32_dpp v23, v16, v16 row_shl:4 row_mask:0xf bank_mask:0x5
    s_nop 1
    v_add_f32_dpp v23, v17, v17 row_shr:4 row_mask:0xf bank_mask:0xa
    v_add_f32_dpp v20, v20, v20 quad_perm:[2,3,0,1] row_mask:0xf bank_mask:0xf
    v_add_f32_dpp v21, v21, v21 quad_perm:[2,3,0,1] row_mask:0xf bank_mask:0xf
    v_add_f32_dpp v22, v22, v22 quad_perm:[2,3,0,1] row_mask:0xf bank_mask:0xf
    v_add_f32_dpp v23, v23, v23 quad_perm:[2,3,0,1] row_mask:0xf bank_mask:0xf
    v_cndmask_b32 v20, v20, v21, s[80:81]
    v_cndmask_b32 v22, v22, v23, s[80:81]
    s_nop 0
    v_add_f32_dpp v20, v20, v20 quad_perm:[1,0,3,2] row_mask:0xf bank_mask:0xf
    v_add_f32_dpp v22, v22, v22 quad_perm:[1,0,3,2] row_mask:0xf bank_mask:0xf
    v_cndmask_b32 v18, v20, v22, s[82:83]
    v_cvt_pk_bf16_f32 v18, v18, v18
    v_and_b32 v18, 0xffff0000, v18
    v_mul_f32 v18, s76, v18
    v_cvt_pk_bf16_f32 v18, v18, v18
    v_and_b32 v18, 0xffff0000, v18
    v_max_f32 v126, v126, v18
    ds_write_b32 v224, v18
    v_add_u32 v224, 256, v224
    s_nop 2
    s_branch L_v2_end
L_v2_1:
    v_dot2_f32_bf16 v12, v128, v8, 0
    v_dot2_f32_bf16 v12, v129, v9, v12
    v_dot2_f32_bf16 v12, v130, v10, v12
    v_dot2_f32_bf16 v12, v131, v11, v12
    s_waitcnt vmcnt(4)
    buffer_load_dwordx4 v[128:131], v4, s[32:35], s72 offen nt
    s_add_u32 s72, s72, 1024
    v_dot2_f32_bf16 v13, v132, v8, 0
    v_dot2_f32_bf16 v13, v133, v9, v13
    v_dot2_f32_bf16 v13, v134, v10, v13
    v_dot2_f32_bf16 v13, v135, v11, v13
    s_waitcnt vmcnt(4)
    buffer_load_dwordx4 v[132:135], v4, s[32:35], s72 offen nt
    s_add_u32 s72, s72, 1024
    v_dot2_f32_bf16 v14, v136, v8, 0
    v_dot2_f32_bf16 v14, v137, v9, v14
    v_dot2_f32_bf16 v14, v138, v10, v14
    v_dot2_f32_bf16 v14, v139, v11, v14
    s_waitcnt vmcnt(4)
    buffer_load_dwordx4 v[136:139], v4, s[32:35], s72 offen nt
    s_add_u32 s72, s72, 1024
    v_dot2_f32_bf16 v15, v140, v8, 0
    v_dot2_f32_bf16 v15, v141, v9, v15
    v_dot2_f32_bf16 v15, v142, v10, v15
    v_dot2_f32_bf16 v15, v143, v11, v15
    s_waitcnt vmcnt(4)
    buffer_load_dwordx4 v[140:143], v4, s[32:35], s72 offen nt
    s_add_u32 s72, s72, 521216
    v_add_f32_dpp v16, v12, v12 row_ror:8 row_mask:0xf bank_mask:0x3
    v_add_f32_dpp v17, v14, v14 row_ror:8 row_mask:0xf bank_mask:0x3
    s_nop 0
    v_add_f32_dpp v16, v13, v13 row_ror:8 row_mask:0xf bank_mask:0xc
    v_add_f32_dpp v17, v15, v15 row_ror:8 row_mask:0xf bank_mask:0xc
    s_nop 0
    v_add_f32_dpp v20, v16, v16 row_shl:4 row_mask:0xf bank_mask:0x5
    s_nop 1
    v_add_f32_dpp v20, v17, v17 row_shr:4 row_mask:0xf bank_mask:0xa
    v_dot2_f32_bf16 v12, v144, v8, 0
    v_dot2_f32_bf16 v12, v145, v9, v12
    v_dot2_f32_bf16 v12, v146, v10, v12
    v_dot2_f32_bf16 v12, v147, v11, v12
    s_waitcnt vmcnt(4)
    buffer_load_dwordx4 v[144:147], v4, s[32:35], s72 offen nt
    s_add_u32 s72, s72, 1024
    v_dot2_f32_bf16 v13, v148, v8, 0
    v_dot2_f32_bf16 v13, v149, v9, v13
    v_dot2_f32_bf16 v13, v150, v10, v13
    v_dot2_f32_bf16 v13, v151, v11, v13
    s_waitcnt vmcnt(4)
    buffer_load_dwordx4 v[148:151], v4, s[32:35], s72 offen nt
    s_add_u32 s72, s72, 1024
    v_dot2_f32_bf16 v14, v152, v8, 0
    v_dot2_f32_bf16 v14, v153, v9, v14
    v_dot2_f32_bf16 v14, v154, v10, v14
    v_dot2_f32_bf16 v14, v155, v11, v14
    s_waitcnt vmcnt(4)
    buffer_load_dwordx4 v[152:155], v4, s[32:35], s72 offen nt
    s_add_u32 s72, s72, 1024
    s_memrealtime s[64:65]
    ds_read_b64 v[242:243], v247 offset:46416
    v_dot2_f32_bf16 v15, v156, v8, 0
    v_dot2_f32_bf16 v15, v157, v9, v15
    v_dot2_f32_bf16 v15, v158, v10, v15
    v_dot2_f32_bf16 v15, v159, v11, v15
    s_waitcnt vmcnt(4)
    buffer_load_dwordx4 v[156:159], v4, s[32:35], s72 offen nt
    s_add_u32 s72, s72, 3666944
    v_add_f32_dpp v16, v12, v12 row_ror:8 row_mask:0xf bank_mask:0x3
    v_add_f32_dpp v17, v14, v14 row_ror:8 row_mask:0xf bank_mask:0x3
    s_nop 0
    v_add_f32_dpp v16, v13, v13 row_ror:8 row_mask:0xf bank_mask:0xc
    v_add_f32_dpp v17, v15, v15 row_ror:8 row_mask:0xf bank_mask:0xc
    s_nop 0
    v_add_f32_dpp v21, v16, v16 row_shl:4 row_mask:0xf bank_mask:0x5
    s_nop 1
    v_add_f32_dpp v21, v17, v17 row_shr:4 row_mask:0xf bank_mask:0xa
    v_dot2_f32_bf16 v12, v160, v8, 0
    v_dot2_f32_bf16 v12, v161, v9, v12
    v_dot2_f32_bf16 v12, v162, v10, v12
    v_dot2_f32_bf16 v12, v163, v11, v12
    s_waitcnt vmcnt(4)
    buffer_load_dwordx4 v[160:163], v4, s[32:35], s72 offen nt
    s_add_u32 s72, s72, 1024
    v_dot2_f32_bf16 v13, v164, v8, 0
    v_dot2_f32_bf16 v13, v165, v9, v13
    v_dot2_f32_bf16 v13, v166, v10, v13
    v_dot2_f32_bf16 v13, v167, v11, v13
    s_waitcnt vmcnt(4)
    buffer_load_dwordx4 v[164:167], v4, s[32:35], s72 offen nt
    s_add_u32 s72, s72, 1024
    v_dot2_f32_bf16 v14, v168, v8, 0
    v_dot2_f32_bf16 v14, v169, v9, v14
    v_dot2_f32_bf16 v14, v170, v10, v14
    v_dot2_f32_bf16 v14, v171, v11, v14
    s_waitcnt vmcnt(4)
    buffer_load_dwordx4 v[168:171], v4, s[32:35], s72 offen nt
    s_add_u32 s72, s72, 1024
    v_dot2_f32_bf16 v15, v172, v8, 0
    v_dot2_f32_bf16 v15, v173, v9, v15
    v_dot2_f32_bf16 v15, v174, v10, v15
    v_dot2_f32_bf16 v15, v175, v11, v15
    s_waitcnt vmcnt(4)
    buffer_load_dwordx4 v[172:175], v4, s[32:35], s72 offen nt
    s_add_u32 s72, s72, 521216
    v_add_f32_dpp v16, v12, v12 row_ror:8 row_mask:0xf bank_mask:0x3
    v_add_f32_dpp v17, v14, v14 row_ror:8 row_mask:0xf bank_mask:0x3
    s_nop 0
    v_add_f32_dpp v16, v13, v13 row_ror:8 row_mask:0xf bank_mask:0xc
    v_add_f32_dpp v17, v15, v15 row_ror:8 row_mask:0xf bank_mask:0xc
    s_nop 0
    v_add_f32_dpp v22, v16, v16 row_shl:4 row_mask:0xf bank_mask:0x5
    s_nop 1
    v_add_f32_dpp v22, v17, v17 row_shr:4 row_mask:0xf bank_mask:0xa
    s_waitcnt lgkmcnt(0)
    v_readfirstlane_b32 s62, v242
    v_readfirstlane_b32 s63, v243
    s_sub_u32 s68, s64, s69
    s_add_u32 s69, s69, 216
    s_add_u32 s67, s67, 1
    v_mov_b32 v244, s68
    v_mov_b32 v245, s67
    ds_write_b64 v246, v[244:245] offset:46432
    s_sub_u32 s68, s68, s62
    s_and_b32 s68, s68, s63
    s_mov_b32 s70, 0
    s_cmp_gt_i32 s68, -60
    s_addc_u32 s70, s70, 0
    s_cmp_gt_i32 s68, 25
    s_addc_u32 s70, s70, 0
    s_cmp_gt_i32 s68, 90
    s_addc_u32 s70, s70, 0
    v_dot2_f32_bf16 v12, v176, v8, 0
    v_dot2_f32_bf16 v12, v177, v9, v12
    v_dot2_f32_bf16 v12, v178, v10, v12
    v_dot2_f32_bf16 v12, v179, v11, v12
    s_waitcnt vmcnt(4)
    buffer_load_dwordx4 v[176:179], v4, s[32:35], s72 offen nt
    s_add_u32 s72, s72, 1024
    v_dot2_f32_bf16 v13, v180, v8, 0
    v_dot2_f32_bf16 v13, v181, v9, v13
    v_dot2_f32_bf16 v13, v182, v10, v13
    v_dot2_f32_bf16 v13, v183, v11, v13
    s_waitcnt vmcnt(4)
    buffer_load_dwordx4 v[180:183], v4, s[32:35], s72 offen nt
    s_add_u32 s72, s72, 1024
    v_dot2_f32_bf16 v14, v184, v8, 0
    v_dot2_f32_bf16 v14, v185, v9, v14
    v_dot2_f32_bf16 v14, v186, v10, v14
    v_dot2_f32_bf16 v14, v187, v11, v14
    s_waitcnt vmcnt(4)
    buffer_load_dwordx4 v[184:187], v4, s[32:35], s72 offen nt
    s_add_u32 s72, s72, 1024
    v_dot2_f32_bf16 v15, v188, v8, 0
    v_dot2_f32_bf16 v15, v189, v9, v15
    v_dot2_f32_bf16 v15, v190, v10, v15
    v_dot2_f32_bf16 v15, v191, v11, v15
    s_waitcnt vmcnt(4)
    buffer_load_dwordx4 v[188:191], v4, s[32:35], s72 offen nt
    s_or_b32 s72, s72, 4291428351
    s_add_u32 s72, s72, 1
    s_and_b32 s72, s72, 3538944
    v_add_f32_dpp v16, v12, v12 row_ror:8 row_mask:0xf bank_mask:0x3
    v_add_f32_dpp v17, v14, v14 row_ror:8 row_mask:0xf bank_mask:0x3
    s_nop 0
    v_add_f32_dpp v16, v13, v13 row_ror:8 row_mask:0xf bank_mask:0xc
    v_add_f32_dpp v17, v15, v15 row_ror:8 row_mask:0xf bank_mask:0xc
    s_nop 0
    v_add_f32_dpp v23, v16, v16 row_shl:4 row_mask:0xf bank_mask:0x5
    s_nop 1
    v_add_f32_dpp v23, v17, v17 row_shr:4 row_mask:0xf bank_mask:0xa
    v_add_f32_dpp v20, v20, v20 quad_perm:[2,3,0,1] row_mask:0xf bank_mask:0xf
    v_add_f32_dpp v21, v21, v21 quad_perm:[2,3,0,1] row_mask:0xf bank_mask:0xf
    v_add_f32_dpp v22, v22, v22 quad_perm:[2,3,0,1] row_mask:0xf bank_mask:0xf
    v_add_f32_dpp v23, v23, v23 quad_perm:[2,3,0,1] row_mask:0xf bank_mask:0xf
    v_cndmask_b32 v20, v20, v21, s[80:81]
    v_cndmask_b32 v22, v22, v23, s[80:81]
    s_nop 0
    v_add_f32_dpp v20, v20, v20 quad_perm:[1,0,3,2] row_mask:0xf bank_mask:0xf
    v_add_f32_dpp v22, v22, v22 quad_perm:[1,0,3,2] row_mask:0xf bank_mask:0xf
    v_cndmask_b32 v18, v20, v22, s[82:83]
    v_cvt_pk_bf16_f32 v18, v18, v18
    v_and_b32 v18, 0xffff0000, v18
    v_mul_f32 v18, s76, v18
    v_cvt_pk_bf16_f32 v18, v18, v18
    v_and_b32 v18, 0xffff0000, v18
    v_max_f32 v126, v126, v18
    ds_write_b32 v224, v18
    v_add_u32 v224, 256, v224
    s_nop 2
    s_branch L_v2_end
L_v2_2:
    v_dot2_f32_bf16 v12, v128, v8, 0
    v_dot2_f32_bf16 v12, v129, v9, v12
    v_dot2_f32_bf16 v12, v130, v10, v12
    v_dot2_f32_bf16 v12, v131, v11, v12
    s_waitcnt vmcnt(5)
    buffer_load_dwordx4 v[128:131], v4, s[32:35], s72 offen nt
    s_add_u32 s72, s72, 1024
    v_dot2_f32_bf16 v13, v132, v8, 0
    v_dot2_f32_bf16 v13, v133, v9, v13
    v_dot2_f32_bf16 v13, v134, v10, v13
    v_dot2_f32_bf16 v13, v135, v11, v13
    s_waitcnt vmcnt(5)
    buffer_load_dwordx4 v[132:135], v4, s[32:35], s72 offen nt
    s_add_u32 s72, s72, 1024
    v_dot2_f32_bf16 v14, v136, v8, 0
    v_dot2_f32_bf16 v14, v137, v9, v14
    v_dot2_f32_bf16 v14, v138, v10, v14
    v_dot2_f32_bf16 v14, v139, v11, v14
    s_waitcnt vmcnt(5)
    buffer_load_dwordx4 v[136:139], v4, s[32:35], s72 offen nt
    s_add_u32 s72, s72, 1024
    v_dot2_f32_bf16 v15, v140, v8, 0
    v_dot2_f32_bf16 v15, v141, v9, v15
    v_dot2_f32_bf16 v15, v142, v10, v15
    v_dot2_f32_bf16 v15, v143, v11, v15
    s_waitcnt vmcnt(5)
    buffer_load_dwordx4 v[140:143], v4, s[32:35], s72 offen nt
    s_add_u32 s72, s72, 521216
    v_add_f32_dpp v16, v12, v12 row_ror:8 row_mask:0xf bank_mask:0x3
    v_add_f32_dpp v17, v14, v14 row_ror:8 row_mask:0xf bank_mask:0x3
    s_nop 0
    v_add_f32_dpp v16, v13, v13 row_ror:8 row_mask:0xf bank_mask:0xc
    v_add_f32_dpp v17, v15, v15 row_ror:8 row_mask:0xf bank_mask:0xc
    s_nop 0
    v_add_f32_dpp v20, v16, v16 row_shl:4 row_mask:0xf bank_mask:0x5
    s_nop 1
    v_add_f32_dpp v20, v17, v17 row_shr:4 row_mask:0xf bank_mask:0xa
    v_dot2_f32_bf16 v12, v144, v8, 0
    v_dot2_f32_bf16 v12, v145, v9, v12
    v_dot2_f32_bf16 v12, v146, v10, v12
    v_dot2_f32_bf16 v12, v147, v11, v12
    s_waitcnt vmcnt(5)
    buffer_load_dwordx4 v[144:147], v4, s[32:35], s72 offen nt
    s_add_u32 s72, s72, 1024
    v_dot2_f32_bf16 v13, v148, v8, 0
    v_dot2_f32_bf16 v13, v149, v9, v13
    v_dot2_f32_bf16 v13, v150, v10, v13
    v_dot2_f32_bf16 v13, v151, v11, v13
    s_waitcnt vmcnt(5)
    buffer_load_dwordx4 v[148:151], v4, s[32:35], s72 offen nt
    s_add_u32 s72, s72, 1024
    v_dot2_f32_bf16 v14, v152, v8, 0
    v_dot2_f32_bf16 v14, v153, v9, v14
    v_dot2_f32_bf16 v14, v154, v10, v14
    v_dot2_f32_bf16 v14, v155, v11, v14
    s_waitcnt vmcnt(5)
    buffer_load_dwordx4 v[152:155], v4, s[32:35], s72 offen nt
    s_add_u32 s72, s72, 1024
    s_memrealtime s[64:65]
    ds_read_b64 v[242:243], v247 offset:46416
    v_dot2_f32_bf16 v15, v156, v8, 0
    v_dot2_f32_bf16 v15, v157, v9, v15
    v_dot2_f32_bf16 v15, v158, v10, v15
    v_dot2_f32_bf16 v15, v159, v11, v15
    s_waitcnt vmcnt(5)
    buffer_load_dwordx4 v[156:159], v4, s[32:35], s72 offen nt
    s_add_u32 s72, s72, 3666944
    v_add_f32_dpp v16, v12, v12 row_ror:8 row_mask:0xf bank_mask:0x3
    v_add_f32_dpp v17, v14, v14 row_ror:8 row_mask:0xf bank_mask:0x3
    s_nop 0
    v_add_f32_dpp v16, v13, v13 row_ror:8 row_mask:0xf bank_mask:0xc
    v_add_f32_dpp v17, v15, v15 row_ror:8 row_mask:0xf bank_mask:0xc
    s_nop 0
    v_add_f32_dpp v21, v16, v16 row_shl:4 row_mask:0xf bank_mask:0x5
    s_nop 1
    v_add_f32_dpp v21, v17, v17 row_shr:4 row_mask:0xf bank_mask:0xa
    v_dot2_f32_bf16 v12, v160, v8, 0
    v_dot2_f32_bf16 v12, v161, v9, v12
    v_dot2_f32_bf16 v12, v162, v10, v12
    v_dot2_f32_bf16 v12, v163, v11, v12
    s_waitcnt vmcnt(5)
    buffer_load_dwordx4 v[160:163], v4, s[32:35], s72 offen nt
    s_add_u32 s72, s72, 1024
    v_dot2_f32_bf16 v13, v164, v8, 0
    v_dot2_f32_bf16 v13, v165, v9, v13
    v_dot2_f32_bf16 v13, v166, v10, v13
    v_dot2_f32_bf16 v13, v167, v11, v13
    s_waitcnt vmcnt(5)
    buffer_load_dwordx4 v[164:167], v4, s[32:35], s72 offen nt
    s_add_u32 s72, s72, 1024
    v_dot2_f32_bf16 v14, v168, v8, 0
    v_dot2_f32_bf16 v14, v169, v9, v14
    v_dot2_f32_bf16 v14, v170, v10, v14
    v_dot2_f32_bf16 v14, v171, v11, v14
    s_waitcnt vmcnt(5)
    buffer_load_dwordx4 v[168:171], v4, s[32:35], s72 offen nt
    s_add_u32 s72, s72, 1024
    v_dot2_f32_bf16 v15, v172, v8, 0
    v_dot2_f32_bf16 v15, v173, v9, v15
    v_dot2_f32_bf16 v15, v174, v10, v15
    v_dot2_f32_bf16 v15, v175, v11, v15
    s_waitcnt vmcnt(5)
    buffer_load_dwordx4 v[172:175], v4, s[32:35], s72 offen nt
    s_add_u32 s72, s72, 521216
    v_add_f32_dpp v16, v12, v12 row_ror:8 row_mask:0xf bank_mask:0x3
    v_add_f32_dpp v17, v14, v14 row_ror:8 row_mask:0xf bank_mask:0x3
    s_nop 0
    v_add_f32_dpp v16, v13, v13 row_ror:8 row_mask:0xf bank_mask:0xc
    v_add_f32_dpp v17, v15, v15 row_ror:8 row_mask:0xf bank_mask:0xc
    s_nop 0
    v_add_f32_dpp v22, v16, v16 row_shl:4 row_mask:0xf bank_mask:0x5
    s_nop 1
    v_add_f32_dpp v22, v17, v17 row_shr:4 row_mask:0xf bank_mask:0xa
    s_waitcnt lgkmcnt(0)
    v_readfirstlane_b32 s62, v242
    v_readfirstlane_b32 s63, v243
    s_sub_u32 s68, s64, s69
    s_add_u32 s69, s69, 216
    s_add_u32 s67, s67, 1
    v_mov_b32 v244, s68
    v_mov_b32 v245, s67
    ds_write_b64 v246, v[244:245] offset:46432
    s_sub_u32 s68, s68, s62
    s_and_b32 s68, s68, s63
    s_mov_b32 s70, 0
    s_cmp_gt_i32 s68, -60
    s_addc_u32 s70, s70, 0
    s_cmp_gt_i32 s68, 25
    s_addc_u32 s70, s70, 0
    s_cmp_gt_i32 s68, 90
    s_addc_u32 s70, s70, 0
    v_dot2_f32_bf16 v12, v176, v8, 0
    v_dot2_f32_bf16 v12, v177, v9, v12
    v_dot2_f32_bf16 v12, v178, v10, v12
    v_dot2_f32_bf16 v12, v179, v11, v12
    s_waitcnt vmcnt(5)
    buffer_load_dwordx4 v[176:179], v4, s[32:35], s72 offen nt
    s_add_u32 s72, s72, 1024
    v_dot2_f32_bf16 v13, v180, v8, 0
    v_dot2_f32_bf16 v13, v181, v9, v13
    v_dot2_f32_bf16 v13, v182, v10, v13
    v_dot2_f32_bf16 v13, v183, v11, v13
    s_waitcnt vmcnt(5)
    buffer_load_dwordx4 v[180:183], v4, s[32:35], s72 offen nt
    s_add_u32 s72, s72, 1024
    v_dot2_f32_bf16 v14, v184, v8, 0
    v_dot2_f32_bf16 v14, v185, v9, v14
    v_dot2_f32_bf16 v14, v186, v10, v14
    v_dot2_f32_bf16 v14, v187, v11, v14
    s_waitcnt vmcnt(5)
    buffer_load_dwordx4 v[184:187], v4, s[32:35], s72 offen nt
    s_add_u32 s72, s72, 1024
    v_dot2_f32_bf16 v15, v188, v8, 0
    v_dot2_f32_bf16 v15, v189, v9, v15
    v_dot2_f32_bf16 v15, v190, v10, v15
    v_dot2_f32_bf16 v15, v191, v11, v15
    s_waitcnt vmcnt(5)
    buffer_load_dwordx4 v[188:191], v4, s[32:35], s72 offen nt
    s_or_b32 s72, s72, 4291428351
    s_add_u32 s72, s72, 1
    s_and_b32 s72, s72, 3538944
    v_add_f32_dpp v16, v12, v12 row_ror:8 row_mask:0xf bank_mask:0x3
    v_add_f32_dpp v17, v14, v14 row_ror:8 row_mask:0xf bank_mask:0x3
    s_nop 0
    v_add_f32_dpp v16, v13, v13 row_ror:8 row_mask:0xf bank_mask:0xc
    v_add_f32_dpp v17, v15, v15 row_ror:8 row_mask:0xf bank_mask:0xc
    s_nop 0
    v_add_f32_dpp v23, v16, v16 row_shl:4 row_mask:0xf bank_mask:0x5
    s_nop 1
    v_add_f32_dpp v23, v17, v17 row_shr:4 row_mask:0xf bank_mask:0xa
    v_add_f32_dpp v20, v20, v20 quad_perm:[2,3,0,1] row_mask:0xf bank_mask:0xf
    v_add_f32_dpp v21, v21, v21 quad_perm:[2,3,0,1] row_mask:0xf bank_mask:0xf
    v_add_f32_dpp v22, v22, v22 quad_perm:[2,3,0,1] row_mask:0xf bank_mask:0xf
    v_add_f32_dpp v23, v23, v23 quad_perm:[2,3,0,1] row_mask:0xf bank_mask:0xf
    v_cndmask_b32 v20, v20, v21, s[80:81]
    v_cndmask_b32 v22, v22, v23, s[80:81]
    s_nop 0
    v_add_f32_dpp v20, v20, v20 quad_perm:[1,0,3,2] row_mask:0xf bank_mask:0xf
    v_add_f32_dpp v22, v22, v22 quad_perm:[1,0,3,2] row_mask:0xf bank_mask:0xf
    v_cndmask_b32 v18, v20, v22, s[82:83]
    v_cvt_pk_bf16_f32 v18, v18, v18
    v_and_b32 v18, 0xffff0000, v18
    v_mul_f32 v18, s76, v18
    v_cvt_pk_bf16_f32 v18, v18, v18
    v_and_b32 v18, 0xffff0000, v18
    v_max_f32 v126, v126, v18
    ds_write_b32 v224, v18
    v_add_u32 v224, 256, v224
    s_nop 2
    s_branch L_v2_end
L_v2_3:
    v_dot2_f32_bf16 v12, v128, v8, 0
    v_dot2_f32_bf16 v12, v129, v9, v12
    v_dot2_f32_bf16 v12, v130, v10, v12
    v_dot2_f32_bf16 v12, v131, v11, v12
    s_waitcnt vmcnt(6)
    buffer_load_dwordx4 v[128:131], v4, s[32:35], s72 offen nt
    s_add_u32 s72, s72, 1024
    v_dot2_f32_bf16 v13, v132, v8, 0
    v_dot2_f32_bf16 v13, v133, v9, v13
    v_dot2_f32_bf16 v13, v134, v10, v13
    v_dot2_f32_bf16 v13, v135, v11, v13
    s_waitcnt vmcnt(6)
    buffer_load_dwordx4 v[132:135], v4, s[32:35], s72 offen nt
    s_add_u32 s72, s72, 1024
    v_dot2_f32_bf16 v14, v136, v8, 0
    v_dot2_f32_bf16 v14, v137, v9, v14
    v_dot2_f32_bf16 v14, v138, v10, v14
    v_dot2_f32_bf16 v14, v139, v11, v14
    s_waitcnt vmcnt(6)
    buffer_load_dwordx4 v[136:139], v4, s[32:35], s72 offen nt
    s_add_u32 s72, s72, 1024
    v_dot2_f32_bf16 v15, v140, v8, 0
    v_dot2_f32_bf16 v15, v141, v9, v15
    v_dot2_f32_bf16 v15, v142, v10, v15
    v_dot2_f32_bf16 v15, v143, v11, v15
    s_waitcnt vmcnt(6)
    buffer_load_dwordx4 v[140:143], v4, s[32:35], s72 offen nt
    s_add_u32 s72, s72, 521216
    v_add_f32_dpp v16, v12, v12 row_ror:8 row_mask:0xf bank_mask:0x3
    v_add_f32_dpp v17, v14, v14 row_ror:8 row_mask:0xf bank_mask:0x3
    s_nop 0
    v_add_f32_dpp v16, v13, v13 row_ror:8 row_mask:0xf bank_mask:0xc
    v_add_f32_dpp v17, v15, v15 row_ror:8 row_mask:0xf bank_mask:0xc
    s_nop 0
    v_add_f32_dpp v20, v16, v16 row_shl:4 row_mask:0xf bank_mask:0x5
    s_nop 1
    v_add_f32_dpp v20, v17, v17 row_shr:4 row_mask:0xf bank_mask:0xa
    v_dot2_f32_bf16 v12, v144, v8, 0
    v_dot2_f32_bf16 v12, v145, v9, v12
    v_dot2_f32_bf16 v12, v146, v10, v12
    v_dot2_f32_bf16 v12, v147, v11, v12
    s_waitcnt vmcnt(6)
    buffer_load_dwordx4 v[144:147], v4, s[32:35], s72 offen nt
    s_add_u32 s72, s72, 1024
    v_dot2_f32_bf16 v13, v148, v8, 0
    v_dot2_f32_bf16 v13, v149, v9, v13
    v_dot2_f32_bf16 v13, v150, v10, v13
    v_dot2_f32_bf16 v13, v151, v11, v13
    s_waitcnt vmcnt(6)
    buffer_load_dwordx4 v[148:151], v4, s[32:35], s72 offen nt
    s_add_u32 s72, s72, 1024
    v_dot2_f32_bf16 v14, v152, v8, 0
    v_dot2_f32_bf16 v14, v153, v9, v14
    v_dot2_f32_bf16 v14, v154, v10, v14
    v_dot2_f32_bf16 v14, v155, v11, v14
    s_waitcnt vmcnt(6)
    buffer_load_dwordx4 v[152:155], v4, s[32:35], s72 offen nt
    s_add_u32 s72, s72, 1024
    s_memrealtime s[64:65]
    ds_read_b64 v[242:243], v247 offset:46416
    v_dot2_f32_bf16 v15, v156, v8, 0
    v_dot2_f32_bf16 v15, v157, v9, v15
    v_dot2_f32_bf16 v15, v158, v10, v15
    v_dot2_f32_bf16 v15, v159, v11, v15
    s_waitcnt vmcnt(6)
    buffer_load_dwordx4 v[156:159], v4, s[32:35], s72 offen nt
    s_add_u32 s72, s72, 3666944
    v_add_f32_dpp v16, v12, v12 row_ror:8 row_mask:0xf bank_mask:0x3
    v_add_f32_dpp v17, v14, v14 row_ror:8 row_mask:0xf bank_mask:0x3
    s_nop 0
    v_add_f32_dpp v16, v13, v13 row_ror:8 row_mask:0xf bank_mask:0xc
    v_add_f32_dpp v17, v15, v15 row_ror:8 row_mask:0xf bank_mask:0xc
    s_nop 0
    v_add_f32_dpp v21, v16, v16 row_shl:4 row_mask:0xf bank_mask:0x5
    s_nop 1
    v_add_f32_dpp v21, v17, v17 row_shr:4 row_mask:0xf bank_mask:0xa
    v_dot2_f32_bf16 v12, v160, v8, 0
    v_dot2_f32_bf16 v12, v161, v9, v12
    v_dot2_f32_bf16 v12, v162, v10, v12
    v_dot2_f32_bf16 v12, v163, v11, v12
    s_waitcnt vmcnt(6)
    buffer_load_dwordx4 v[160:163], v4, s[32:35], s72 offen nt
    s_add_u32 s72, s72, 1024
    v_dot2_f32_bf16 v13, v164, v8, 0
    v_dot2_f32_bf16 v13, v165, v9, v13
    v_dot2_f32_bf16 v13, v166, v10, v13
    v_dot2_f32_bf16 v13, v167, v11, v13
    s_waitcnt vmcnt(6)
    buffer_load_dwordx4 v[164:167], v4, s[32:35], s72 offen nt
    s_add_u32 s72, s72, 1024
    v_dot2_f32_bf16 v14, v168, v8, 0
    v_dot2_f32_bf16 v14, v169, v9, v14
    v_dot2_f32_bf16 v14, v170, v10, v14
    v_dot2_f32_bf16 v14, v171, v11, v14
    s_waitcnt vmcnt(6)
    buffer_load_dwordx4 v[168:171], v4, s[32:35], s72 offen nt
    s_add_u32 s72, s72, 1024
    v_dot2_f32_bf16 v15, v172, v8, 0
    v_dot2_f32_bf16 v15, v173, v9, v15
    v_dot2_f32_bf16 v15, v174, v10, v15
    v_dot2_f32_bf16 v15, v175, v11, v15
    s_waitcnt vmcnt(6)
    buffer_load_dwordx4 v[172:175], v4, s[32:35], s72 offen nt
    s_add_u32 s72, s72, 521216
    v_add_f32_dpp v16, v12, v12 row_ror:8 row_mask:0xf bank_mask:0x3
    v_add_f32_dpp v17, v14, v14 row_ror:8 row_mask:0xf bank_mask:0x3
    s_nop 0
    v_add_f32_dpp v16, v13, v13 row_ror:8 row_mask:0xf bank_mask:0xc
    v_add_f32_dpp v17, v15, v15 row_ror:8 row_mask:0xf bank_mask:0xc
    s_nop 0
    v_add_f32_dpp v22, v16, v16 row_shl:4 row_mask:0xf bank_mask:0x5
    s_nop 1
    v_add_f32_dpp v22, v17, v17 row_shr:4 row_mask:0xf bank_mask:0xa
    s_waitcnt lgkmcnt(0)
    v_readfirstlane_b32 s62, v242
    v_readfirstlane_b32 s63, v243
    s_sub_u32 s68, s64, s69
    s_add_u32 s69, s69, 216
    s_add_u32 s67, s67, 1
    v_mov_b32 v244, s68
    v_mov_b32 v245, s67
    ds_write_b64 v246, v[244:245] offset:46432
    s_sub_u32 s68, s68, s62
    s_and_b32 s68, s68, s63
    s_mov_b32 s70, 0
    s_cmp_gt_i32 s68, -60
    s_addc_u32 s70, s70, 0
    s_cmp_gt_i32 s68, 25
    s_addc_u32 s70, s70, 0
    s_cmp_gt_i32 s68, 90
    s_addc_u32 s70, s70, 0
    v_dot2_f32_bf16 v12, v176, v8, 0
    v_dot2_f32_bf16 v12, v177, v9, v12
    v_dot2_f32_bf16 v12, v178, v10, v12
    v_dot2_f32_bf16 v12, v179, v11, v12
    s_waitcnt vmcnt(6)
    buffer_load_dwordx4 v[176:179], v4, s[32:35], s72 offen nt
    s_add_u32 s72, s72, 1024
    v_dot2_f32_bf16 v13, v180, v8, 0
    v_dot2_f32_bf16 v13, v181, v9, v13
    v_dot2_f32_bf16 v13, v182, v10, v13
    v_dot2_f32_bf16 v13, v183, v11, v13
    s_waitcnt vmcnt(6)
    buffer_load_dwordx4 v[180:183], v4, s[32:35], s72 offen nt
    s_add_u32 s72, s72, 1024
    v_dot2_f32_bf16 v14, v184, v8, 0
    v_dot2_f32_bf16 v14, v185, v9, v14
    v_dot2_f32_bf16 v14, v186, v10, v14
    v_dot2_f32_bf16 v14, v187, v11, v14
    s_waitcnt vmcnt(6)
    buffer_load_dwordx4 v[184:187], v4, s[32:35], s72 offen nt
    s_add_u32 s72, s72, 1024
    v_dot2_f32_bf16 v15, v188, v8, 0
    v_dot2_f32_bf16 v15, v189, v9, v15
    v_dot2_f32_bf16 v15, v190, v10, v15
    v_dot2_f32_bf16 v15, v191, v11, v15
    s_waitcnt vmcnt(6)
    buffer_load_dwordx4 v[188:191], v4, s[32:35], s72 offen nt
    s_or_b32 s72, s72, 4291428351
    s_add_u32 s72, s72, 1
    s_and_b32 s72, s72, 3538944
    v_add_f32_dpp v16, v12, v12 row_ror:8 row_mask:0xf bank_mask:0x3
    v_add_f32_dpp v17, v14, v14 row_ror:8 row_mask:0xf bank_mask:0x3
    s_nop 0
    v_add_f32_dpp v16, v13, v13 row_ror:8 row_mask:0xf bank_mask:0xc
    v_add_f32_dpp v17, v15, v15 row_ror:8 row_mask:0xf bank_mask:0xc
    s_nop 0
    v_add_f32_dpp v23, v16, v16 row_shl:4 row_mask:0xf bank_mask:0x5
    s_nop 1
    v_add_f32_dpp v23, v17, v17 row_shr:4 row_mask:0xf bank_mask:0xa
    v_add_f32_dpp v20, v20, v20 quad_perm:[2,3,0,1] row_mask:0xf bank_mask:0xf
    v_add_f32_dpp v21, v21, v21 quad_perm:[2,3,0,1] row_mask:0xf bank_mask:0xf
    v_add_f32_dpp v22, v22, v22 quad_perm:[2,3,0,1] row_mask:0xf bank_mask:0xf
    v_add_f32_dpp v23, v23, v23 quad_perm:[2,3,0,1] row_mask:0xf bank_mask:0xf
    v_cndmask_b32 v20, v20, v21, s[80:81]
    v_cndmask_b32 v22, v22, v23, s[80:81]
    s_nop 0
    v_add_f32_dpp v20, v20, v20 quad_perm:[1,0,3,2] row_mask:0xf bank_mask:0xf
    v_add_f32_dpp v22, v22, v22 quad_perm:[1,0,3,2] row_mask:0xf bank_mask:0xf
    v_cndmask_b32 v18, v20, v22, s[82:83]
    v_cvt_pk_bf16_f32 v18, v18, v18
    v_and_b32 v18, 0xffff0000, v18
    v_mul_f32 v18, s76, v18
    v_cvt_pk_bf16_f32 v18, v18, v18
    v_and_b32 v18, 0xffff0000, v18
    v_max_f32 v126, v126, v18
    ds_write_b32 v224, v18
    v_add_u32 v224, 256, v224
    s_nop 2
L_v2_end:
    s_sub_u32 s73, s73, 1
    s_cmp_lg_u32 s73, 0
    s_cbranch_scc1 L_kloop
    v_max_f32_dpp v126, v126, v126 row_ror:8 row_mask:0xf bank_mask:0xf
    s_nop 1
    v_max_f32_dpp v126, v126, v126 row_ror:4 row_mask:0xf bank_mask:0xf
    s_nop 1
    v_max_f32_dpp v126, v126, v126 row_ror:2 row_mask:0xf bank_mask:0xf
    s_nop 1
    v_max_f32_dpp v126, v126, v126 row_ror:1 row_mask:0xf bank_mask:0xf
    v_mov_b32 v13, v126
    s_nop 1
    v_permlane16_swap_b32 v126, v13
    v_max_f32 v126, v126, v13
    v_mov_b32 v13, v126
    s_nop 1
    v_permlane32_swap_b32 v126, v13
    v_max_f32 v126, v126, v13
    s_lshl_b32 s31, s3, 2
    v_mov_b32 v13, s31
    ds_write_b32 v13, v126 offset:46336
    v_subrev_u32 v224, 8192, v224
    ds_read_b32 v125, v224
    v_mov_b32 v226, v126
    s_mov_b32 s76, 1069066811
    s_waitcnt lgkmcnt(0)
    v_sub_f32 v125, v125, v226
    v_mul_f32 v125, s76, v125
    v_exp_f32 v125, v125
    s_nop 0
    v_add_f32 v127, v127, v125
    v_cvt_pk_bf16_f32 v125, v125, v125
    v_mov_b32 v124, v125
    v_mov_b32 v12, 0
    v_mov_b32 v13, 0
    v_mov_b32 v14, 0
    v_mov_b32 v15, 0
    v_and_b32_dpp v24, v124, v120 row_newbcast:0 row_mask:0xf bank_mask:0xf
    v_and_b32_dpp v25, v124, v121 row_newbcast:0 row_mask:0xf bank_mask:0xf
    v_and_b32_dpp v26, v124, v122 row_newbcast:0 row_mask:0xf bank_mask:0xf
    v_and_b32_dpp v27, v124, v123 row_newbcast:0 row_mask:0xf bank_mask:0xf
    s_mov_b32 s73, 15
L_vloop:
    s_nop 1
    s_cmp_eq_u32 s70, 1
    s_cbranch_scc1 L_v3_1
    s_cmp_eq_u32 s70, 2
    s_cbranch_scc1 L_v3_2
    s_cmp_eq_u32 s70, 3
    s_cbranch_scc1 L_v3_3
    v_add_u32 v224, 256, v224
    ds_read_b32 v125, v224
    v_and_b32_dpp v28, v124, v120 row_newbcast:8 row_mask:0xf bank_mask:0xf
    v_and_b32_dpp v29, v124, v121 row_newbcast:8 row_mask:0xf bank_mask:0xf
    v_and_b32_dpp v30, v124, v122 row_newbcast:8 row_mask:0xf bank_mask:0xf
    v_and_b32_dpp v31, v124, v123 row_newbcast:8 row_mask:0xf bank_mask:0xf
    v_mfma_f32_16x16x32_bf16 v[12:15], v[24:27], v[32:35], v[12:15]
    s_waitcnt vmcnt(3)
    buffer_load_dwordx4 v[32:35], v4, s[32:35], s72 offen nt
    s_add_u32 s72, s72, 1024
    v_and_b32_dpp v24, v124, v120 row_newbcast:4 row_mask:0xf bank_mask:0xf
    v_and_b32_dpp v25, v124, v121 row_newbcast:4 row_mask:0xf bank_mask:0xf
    v_and_b32_dpp v26, v124, v122 row_newbcast:4 row_mask:0xf bank_mask:0xf
    v_and_b32_dpp v27, v124, v123 row_newbcast:4 row_mask:0xf bank_mask:0xf
    v_mfma_f32_16x16x32_bf16 v[12:15], v[28:31], v[36:39], v[12:15]
    s_waitcnt vmcnt(3)
    buffer_load_dwordx4 v[36:39], v4, s[32:35], s72 offen nt
    s_add_u32 s72, s72, 1024
    v_and_b32_dpp v28, v124, v120 row_newbcast:12 row_mask:0xf bank_mask:0xf
    v_and_b32_dpp v29, v124, v121 row_newbcast:12 row_mask:0xf bank_mask:0xf
    v_and_b32_dpp v30, v124, v122 row_newbcast:12 row_mask:0xf bank_mask:0xf
    v_and_b32_dpp v31, v124, v123 row_newbcast:12 row_mask:0xf bank_mask:0xf
    v_mfma_f32_16x16x32_bf16 v[12:15], v[24:27], v[40:43], v[12:15]
    s_waitcnt vmcnt(3)
    buffer_load_dwordx4 v[40:43], v4, s[32:35], s72 offen nt
    s_add_u32 s72, s72, 1024
    v_and_b32_dpp v24, v124, v120 row_newbcast:2 row_mask:0xf bank_mask:0xf
    v_and_b32_dpp v25, v124, v121 row_newbcast:2 row_mask:0xf bank_mask:0xf
    v_and_b32_dpp v26, v124, v122 row_newbcast:2 row_mask:0xf bank_mask:0xf
    v_and_b32_dpp v27, v124, v123 row_newbcast:2 row_mask:0xf bank_mask:0xf
    v_mfma_f32_16x16x32_bf16 v[12:15], v[28:31], v[44:47], v[12:15]
    s_waitcnt vmcnt(3)
    buffer_load_dwordx4 v[44:47], v4, s[32:35], s72 offen nt
    s_add_u32 s72, s72, 521216
    v_and_b32_dpp v28, v124, v120 row_newbcast:10 row_mask:0xf bank_mask:0xf
    v_and_b32_dpp v29, v124, v121 row_newbcast:10 row_mask:0xf bank_mask:0xf
    v_and_b32_dpp v30, v124, v122 row_newbcast:10 row_mask:0xf bank_mask:0xf
    v_and_b32_dpp v31, v124, v123 row_newbcast:10 row_mask:0xf bank_mask:0xf
    v_mfma_f32_16x16x32_bf16 v[12:15], v[24:27], v[48:51], v[12:15]
    s_waitcnt vmcnt(3)
    buffer_load_dwordx4 v[48:51], v4, s[32:35], s72 offen nt
    s_add_u32 s72, s72, 1024
    v_and_b32_dpp v24, v124, v120 row_newbcast:6 row_mask:0xf bank_mask:0xf
    v_and_b32_dpp v25, v124, v121 row_newbcast:6 row_mask:0xf bank_mask:0xf
    v_and_b32_dpp v26, v124, v122 row_newbcast:6 row_mask:0xf bank_mask:0xf
    v_and_b32_dpp v27, v124, v123 row_newbcast:6 row_mask:0xf bank_mask:0xf
    v_mfma_f32_16x16x32_bf16 v[12:15], v[28:31], v[52:55], v[12:15]
    s_waitcnt vmcnt(3)
    buffer_load_dwordx4 v[52:55], v4, s[32:35], s72 offen nt
    s_add_u32 s72, s72, 1024
    s_waitcnt lgkmcnt(0)
    v_sub_f32 v125, v125, v226
    v_mul_f32 v125, s76, v125
    v_exp_f32 v125, v125
    s_nop 0
    v_add_f32 v127, v127, v125
    v_cvt_pk_bf16_f32 v125, v125, v125
    v_and_b32_dpp v28, v124, v120 row_newbcast:14 row_mask:0xf bank_mask:0xf
    v_and_b32_dpp v29, v124, v121 row_newbcast:14 row_mask:0xf bank_mask:0xf
    v_and_b32_dpp v30, v124, v122 row_newbcast:14 row_mask:0xf bank_mask:0xf
    v_and_b32_dpp v31, v124, v123 row_newbcast:14 row_mask:0xf bank_mask:0xf
    v_mfma_f32_16x16x32_bf16 v[12:15], v[24:27], v[56:59], v[12:15]
    s_waitcnt vmcnt(3)
    buffer_load_dwordx4 v[56:59], v4, s[32:35], s72 offen nt
    s_add_u32 s72, s72, 1024
    s_memrealtime s[64:65]
    ds_read_b64 v[242:243], v247 offset:46416
    v_and_b32_dpp v24, v124, v120 row_newbcast:1 row_mask:0xf bank_mask:0xf
    v_and_b32_dpp v25, v124, v121 row_newbcast:1 row_mask:0xf bank_mask:0xf
    v_and_b32_dpp v26, v124, v122 row_newbcast:1 row_mask:0xf bank_mask:0xf
    v_and_b32_dpp v27, v124, v123 row_newbcast:1 row_mask:0xf bank_mask:0xf
    v_mfma_f32_16x16x32_bf16 v[12:15], v[28:31], v[60:63], v[12:15]
    s_waitcnt vmcnt(3)
    buffer_load_dwordx4 v[60:63], v4, s[32:35], s72 offen nt
    s_add_u32 s72, s72, 3666944
    v_and_b32_dpp v28, v124, v120 row_newbcast:9 row_mask:0xf bank_mask:0xf
    v_and_b32_dpp v29, v124, v121 row_newbcast:9 row_mask:0xf bank_mask:0xf
    v_and_b32_dpp v30, v124, v122 row_newbcast:9 row_mask:0xf bank_mask:0xf
    v_and_b32_dpp v31, v124, v123 row_newbcast:9 row_mask:0xf bank_mask:0xf
    v_mfma_f32_16x16x32_bf16 v[12:15], v[24:27], v[64:67], v[12:15]
    s_waitcnt vmcnt(3)
    buffer_load_dwordx4 v[64:67], v4, s[32:35], s72 offen nt
    s_add_u32 s72, s72, 1024
    v_and_b32_dpp v24, v124, v120 row_newbcast:5 row_mask:0xf bank_mask:0xf
    v_and_b32_dpp v25, v124, v121 row_newbcast:5 row_mask:0xf bank_mask:0xf
    v_and_b32_dpp v26, v124, v122 row_newbcast:5 row_mask:0xf bank_mask:0xf
    v_and_b32_dpp v27, v124, v123 row_newbcast:5 row_mask:0xf bank_mask:0xf
    v_mfma_f32_16x16x32_bf16 v[12:15], v[28:31], v[68:71], v[12:15]
    s_waitcnt vmcnt(3)
    buffer_load_dwordx4 v[68:71], v4, s[32:35], s72 offen nt
    s_add_u32 s72, s72, 1024
    v_and_b32_dpp v28, v124, v120 row_newbcast:13 row_mask:0xf bank_mask:0xf
    v_and_b32_dpp v29, v124, v121 row_newbcast:13 row_mask:0xf bank_mask:0xf
    v_and_b32_dpp v30, v124, v122 row_newbcast:13 row_mask:0xf bank_mask:0xf
    v_and_b32_dpp v31, v124, v123 row_newbcast:13 row_mask:0xf bank_mask:0xf
    v_mfma_f32_16x16x32_bf16 v[12:15], v[24:27], v[72:75], v[12:15]
    s_waitcnt vmcnt(3)
    buffer_load_dwordx4 v[72:75], v4, s[32:35], s72 offen nt
    s_add_u32 s72, s72, 1024
    v_and_b32_dpp v24, v124, v120 row_newbcast:3 row_mask:0xf bank_mask:0xf
    v_and_b32_dpp v25, v124, v121 row_newbcast:3 row_mask:0xf bank_mask:0xf
    v_and_b32_dpp v26, v124, v122 row_newbcast:3 row_mask:0xf bank_mask:0xf
    v_and_b32_dpp v27, v124, v123 row_newbcast:3 row_mask:0xf bank_mask:0xf
    v_mfma_f32_16x16x32_bf16 v[12:15], v[28:31], v[76:79], v[12:15]
    s_waitcnt vmcnt(3)
    buffer_load_dwordx4 v[76:79], v4, s[32:35], s72 offen nt
    s_add_u32 s72, s72, 521216
    s_waitcnt lgkmcnt(0)
    v_readfirstlane_b32 s62, v242
    v_readfirstlane_b32 s63, v243
    s_sub_u32 s68, s64, s69
    s_add_u32 s69, s69, 216
    s_add_u32 s67, s67, 1
    v_mov_b32 v244, s68
    v_mov_b32 v245, s67
    ds_write_b64 v246, v[244:245] offset:46432
    s_sub_u32 s68, s68, s62
    s_and_b32 s68, s68, s63
    s_mov_b32 s70, 0
    s_cmp_gt_i32 s68, -60
    s_addc_u32 s70, s70, 0
    s_cmp_gt_i32 s68, 25
    s_addc_u32 s70, s70, 0
    s_cmp_gt_i32 s68, 90
    s_addc_u32 s70, s70, 0
    v_and_b32_dpp v28, v124, v120 row_newbcast:11 row_mask:0xf bank_mask:0xf
    v_and_b32_dpp v29, v124, v121 row_newbcast:11 row_mask:0xf bank_mask:0xf
    v_and_b32_dpp v30, v124, v122 row_newbcast:11 row_mask:0xf bank_mask:0xf
    v_and_b32_dpp v31, v124, v123 row_newbcast:11 row_mask:0xf bank_mask:0xf
    v_mfma_f32_16x16x32_bf16 v[12:15], v[24:27], v[80:83], v[12:15]
    s_waitcnt vmcnt(3)
    buffer_load_dwordx4 v[80:83], v4, s[32:35], s72 offen nt
    s_add_u32 s72, s72, 1024
    v_and_b32_dpp v24, v124, v120 row_newbcast:7 row_mask:0xf bank_mask:0xf
    v_and_b32_dpp v25, v124, v121 row_newbcast:7 row_mask:0xf bank_mask:0xf
    v_and_b32_dpp v26, v124, v122 row_newbcast:7 row_mask:0xf bank_mask:0xf
    v_and_b32_dpp v27, v124, v123 row_newbcast:7 row_mask:0xf bank_mask:0xf
    v_mfma_f32_16x16x32_bf16 v[12:15], v[28:31], v[84:87], v[12:15]
    s_waitcnt vmcnt(3)
    buffer_load_dwordx4 v[84:87], v4, s[32:35], s72 offen nt
    s_add_u32 s72, s72, 1024
    v_and_b32_dpp v28, v124, v120 row_newbcast:15 row_mask:0xf bank_mask:0xf
    v_and_b32_dpp v29, v124, v121 row_newbcast:15 row_mask:0xf bank_mask:0xf
    v_and_b32_dpp v30, v124, v122 row_newbcast:15 row_mask:0xf bank_mask:0xf
    v_and_b32_dpp v31, v124, v123 row_newbcast:15 row_mask:0xf bank_mask:0xf
    v_mfma_f32_16x16x32_bf16 v[12:15], v[24:27], v[88:91], v[12:15]
    s_waitcnt vmcnt(3)
    buffer_load_dwordx4 v[88:91], v4, s[32:35], s72 offen nt
    s_add_u32 s72, s72, 1024
    v_and_b32_dpp v24, v125, v120 row_newbcast:0 row_mask:0xf bank_mask:0xf
    v_and_b32_dpp v25, v125, v121 row_newbcast:0 row_mask:0xf bank_mask:0xf
    v_and_b32_dpp v26, v125, v122 row_newbcast:0 row_mask:0xf bank_mask:0xf
    v_and_b32_dpp v27, v125, v123 row_newbcast:0 row_mask:0xf bank_mask:0xf
    v_mov_b32 v124, v125
    v_mfma_f32_16x16x32_bf16 v[12:15], v[28:31], v[92:95], v[12:15]
    s_waitcnt vmcnt(3)
    buffer_load_dwordx4 v[92:95], v4, s[32:35], s72 offen nt
    s_add_u32 s72, s72, 3666944
    s_nop 4
    s_branch L_v3_end
L_v3_1:
    v_add_u32 v224, 256, v224
    ds_read_b32 v125, v224
    v_and_b32_dpp v28, v124, v120 row_newbcast:8 row_mask:0xf bank_mask:0xf
    v_and_b32_dpp v29, v124, v121 row_newbcast:8 row_mask:0xf bank_mask:0xf
    v_and_b32_dpp v30, v124, v122 row_newbcast:8 row_mask:0xf bank_mask:0xf
    v_and_b32_dpp v31, v124, v123 row_newbcast:8 row_mask:0xf bank_mask:0xf
    v_mfma_f32_16x16x32_bf16 v[12:15], v[24:27], v[32:35], v[12:15]
    s_waitcnt vmcnt(4)
    buffer_load_dwordx4 v[32:35], v4, s[32:35], s72 offen nt
    s_add_u32 s72, s72, 1024
    v_and_b32_dpp v24, v124, v120 row_newbcast:4 row_mask:0xf bank_mask:0xf
    v_and_b32_dpp v25, v124, v121 row_newbcast:4 row_mask:0xf bank_mask:0xf
    v_and_b32_dpp v26, v124, v122 row_newbcast:4 row_mask:0xf bank_mask:0xf
    v_and_b32_dpp v27, v124, v123 row_newbcast:4 row_mask:0xf bank_mask:0xf
    v_mfma_f32_16x16x32_bf16 v[12:15], v[28:31], v[36:39], v[12:15]
    s_waitcnt vmcnt(4)
    buffer_load_dwordx4 v[36:39], v4, s[32:35], s72 offen nt
    s_add_u32 s72, s72, 1024
    v_and_b32_dpp v28, v124, v120 row_newbcast:12 row_mask:0xf bank_mask:0xf
    v_and_b32_dpp v29, v124, v121 row_newbcast:12 row_mask:0xf bank_mask:0xf
    v_and_b32_dpp v30, v124, v122 row_newbcast:12 row_mask:0xf bank_mask:0xf
    v_and_b32_dpp v31, v124, v123 row_newbcast:12 row_mask:0xf bank_mask:0xf
    v_mfma_f32_16x16x32_bf16 v[12:15], v[24:27], v[40:43], v[12:15]
    s_waitcnt vmcnt(4)
    buffer_load_dwordx4 v[40:43], v4, s[32:35], s72 offen nt
    s_add_u32 s72, s72, 1024
    v_and_b32_dpp v24, v124, v120 row_newbcast:2 row_mask:0xf bank_mask:0xf
    v_and_b32_dpp v25, v124, v121 row_newbcast:2 row_mask:0xf bank_mask:0xf
    v_and_b32_dpp v26, v124, v122 row_newbcast:2 row_mask:0xf bank_mask:0xf
    v_and_b32_dpp v27, v124, v123 row_newbcast:2 row_mask:0xf bank_mask:0xf
    v_mfma_f32_16x16x32_bf16 v[12:15], v[28:31], v[44:47], v[12:15]
    s_waitcnt vmcnt(4)
    buffer_load_dwordx4 v[44:47], v4, s[32:35], s72 offen nt
    s_add_u32 s72, s72, 521216
    v_and_b32_dpp v28, v124, v120 row_newbcast:10 row_mask:0xf bank_mask:0xf
    v_and_b32_dpp v29, v124, v121 row_newbcast:10 row_mask:0xf bank_mask:0xf
    v_and_b32_dpp v30, v124, v122 row_newbcast:10 row_mask:0xf bank_mask:0xf
    v_and_b32_dpp v31, v124, v123 row_newbcast:10 row_mask:0xf bank_mask:0xf
    v_mfma_f32_16x16x32_bf16 v[12:15], v[24:27], v[48:51], v[12:15]
    s_waitcnt vmcnt(4)
    buffer_load_dwordx4 v[48:51], v4, s[32:35], s72 offen nt
    s_add_u32 s72, s72, 1024
    v_and_b32_dpp v24, v124, v120 row_newbcast:6 row_mask:0xf bank_mask:0xf
    v_and_b32_dpp v25, v124, v121 row_newbcast:6 row_mask:0xf bank_mask:0xf
    v_and_b32_dpp v26, v124, v122 row_newbcast:6 row_mask:0xf bank_mask:0xf
    v_and_b32_dpp v27, v124, v123 row_newbcast:6 row_mask:0xf bank_mask:0xf
    v_mfma_f32_16x16x32_bf16 v[12:15], v[28:31], v[52:55], v[12:15]
    s_waitcnt vmcnt(4)
    buffer_load_dwordx4 v[52:55], v4, s[32:35], s72 offen nt
    s_add_u32 s72, s72, 1024
    s_waitcnt lgkmcnt(0)
    v_sub_f32 v125, v125, v226
    v_mul_f32 v125, s76, v125
    v_exp_f32 v125, v125
    s_nop 0
    v_add_f32 v127, v127, v125
    v_cvt_pk_bf16_f32 v125, v125, v125
    v_and_b32_dpp v28, v124, v120 row_newbcast:14 row_mask:0xf bank_mask:0xf
    v_and_b32_dpp v29, v124, v121 row_newbcast:14 row_mask:0xf bank_mask:0xf
    v_and_b32_dpp v30, v124, v122 row_newbcast:14 row_mask:0xf bank_mask:0xf
    v_and_b32_dpp v31, v124, v123 row_newbcast:14 row_mask:0xf bank_mask:0xf
    v_mfma_f32_16x16x32_bf16 v[12:15], v[24:27], v[56:59], v[12:15]
    s_waitcnt vmcnt(4)
    buffer_load_dwordx4 v[56:59], v4, s[32:35], s72 offen nt
    s_add_u32 s72, s72, 1024
    s_memrealtime s[64:65]
    ds_read_b64 v[242:243], v247 offset:46416
    v_and_b32_dpp v24, v124, v120 row_newbcast:1 row_mask:0xf bank_mask:0xf
    v_and_b32_dpp v25, v124, v121 row_newbcast:1 row_mask:0xf bank_mask:0xf
    v_and_b32_dpp v26, v124, v122 row_newbcast:1 row_mask:0xf bank_mask:0xf
    v_and_b32_dpp v27, v124, v123 row_newbcast:1 row_mask:0xf bank_mask:0xf
    v_mfma_f32_16x16x32_bf16 v[12:15], v[28:31], v[60:63], v[12:15]
    s_waitcnt vmcnt(4)
    buffer_load_dwordx4 v[60:63], v4, s[32:35], s72 offen nt
    s_add_u32 s72, s72, 3666944
    v_and_b32_dpp v28, v124, v120 row_newbcast:9 row_mask:0xf bank_mask:0xf
    v_and_b32_dpp v29, v124, v121 row_newbcast:9 row_mask:0xf bank_mask:0xf
    v_and_b32_dpp v30, v124, v122 row_newbcast:9 row_mask:0xf bank_mask:0xf
    v_and_b32_dpp v31, v124, v123 row_newbcast:9 row_mask:0xf bank_mask:0xf
    v_mfma_f32_16x16x32_bf16 v[12:15], v[24:27], v[64:67], v[12:15]
    s_waitcnt vmcnt(4)
    buffer_load_dwordx4 v[64:67], v4, s[32:35], s72 offen nt
    s_add_u32 s72, s72, 1024
    v_and_b32_dpp v24, v124, v120 row_newbcast:5 row_mask:0xf bank_mask:0xf
    v_and_b32_dpp v25, v124, v121 row_newbcast:5 row_mask:0xf bank_mask:0xf
    v_and_b32_dpp v26, v124, v122 row_newbcast:5 row_mask:0xf bank_mask:0xf
    v_and_b32_dpp v27, v124, v123 row_newbcast:5 row_mask:0xf bank_mask:0xf
    v_mfma_f32_16x16x32_bf16 v[12:15], v[28:31], v[68:71], v[12:15]
    s_waitcnt vmcnt(4)
    buffer_load_dwordx4 v[68:71], v4, s[32:35], s72 offen nt
    s_add_u32 s72, s72, 1024
    v_and_b32_dpp v28, v124, v120 row_newbcast:13 row_mask:0xf bank_mask:0xf
    v_and_b32_dpp v29, v124, v121 row_newbcast:13 row_mask:0xf bank_mask:0xf
    v_and_b32_dpp v30, v124, v122 row_newbcast:13 row_mask:0xf bank_mask:0xf
    v_and_b32_dpp v31, v124, v123 row_newbcast:13 row_mask:0xf bank_mask:0xf
    v_mfma_f32_16x16x32_bf16 v[12:15], v[24:27], v[72:75], v[12:15]
    s_waitcnt vmcnt(4)
    buffer_load_dwordx4 v[72:75], v4, s[32:35], s72 offen nt
    s_add_u32 s72, s72, 1024
    v_and_b32_dpp v24, v124, v120 row_newbcast:3 row_mask:0xf bank_mask:0xf
    v_and_b32_dpp v25, v124, v121 row_newbcast:3 row_mask:0xf bank_mask:0xf
    v_and_b32_dpp v26, v124, v122 row_newbcast:3 row_mask:0xf bank_mask:0xf
    v_and_b32_dpp v27, v124, v123 row_newbcast:3 row_mask:0xf bank_mask:0xf
    v_mfma_f32_16x16x32_bf16 v[12:15], v[28:31], v[76:79], v[12:15]
    s_waitcnt vmcnt(4)
    buffer_load_dwordx4 v[76:79], v4, s[32:35], s72 offen nt
    s_add_u32 s72, s72, 521216
    s_waitcnt lgkmcnt(0)
    v_readfirstlane_b32 s62, v242
    v_readfirstlane_b32 s63, v243
    s_sub_u32 s68, s64, s69
    s_add_u32 s69, s69, 216
    s_add_u32 s67, s67, 1
    v_mov_b32 v244, s68
    v_mov_b32 v245, s67
    ds_write_b64 v246, v[244:245] offset:46432
    s_sub_u32 s68, s68, s62
    s_and_b32 s68, s68, s63
    s_mov_b32 s70, 0
    s_cmp_gt_i32 s68, -60
    s_addc_u32 s70, s70, 0
    s_cmp_gt_i32 s68, 25
    s_addc_u32 s70, s70, 0
    s_cmp_gt_i32 s68, 90
    s_addc_u32 s70, s70, 0
    v_and_b32_dpp v28, v124, v120 row_newbcast:11 row_mask:0xf bank_mask:0xf
    v_and_b32_dpp v29, v124, v121 row_newbcast:11 row_mask:0xf bank_mask:0xf
    v_and_b32_dpp v30, v124, v122 row_newbcast:11 row_mask:0xf bank_mask:0xf
    v_and_b32_dpp v31, v124, v123 row_newbcast:11 row_mask:0xf bank_mask:0xf
    v_mfma_f32_16x16x32_bf16 v[12:15], v[24:27], v[80:83], v[12:15]
    s_waitcnt vmcnt(4)
    buffer_load_dwordx4 v[80:83], v4, s[32:35], s72 offen nt
    s_add_u32 s72, s72, 1024
    v_and_b32_dpp v24, v124, v120 row_newbcast:7 row_mask:0xf bank_mask:0xf
    v_and_b32_dpp v25, v124, v121 row_newbcast:7 row_mask:0xf bank_mask:0xf
    v_and_b32_dpp v26, v124, v122 row_newbcast:7 row_mask:0xf bank_mask:0xf
    v_and_b32_dpp v27, v124, v123 row_newbcast:7 row_mask:0xf bank_mask:0xf
    v_mfma_f32_16x16x32_bf16 v[12:15], v[28:31], v[84:87], v[12:15]
    s_waitcnt vmcnt(4)
    buffer_load_dwordx4 v[84:87], v4, s[32:35], s72 offen nt
    s_add_u32 s72, s72, 1024
    v_and_b32_dpp v28, v124, v120 row_newbcast:15 row_mask:0xf bank_mask:0xf
    v_and_b32_dpp v29, v124, v121 row_newbcast:15 row_mask:0xf bank_mask:0xf
    v_and_b32_dpp v30, v124, v122 row_newbcast:15 row_mask:0xf bank_mask:0xf
    v_and_b32_dpp v31, v124, v123 row_newbcast:15 row_mask:0xf bank_mask:0xf
    v_mfma_f32_16x16x32_bf16 v[12:15], v[24:27], v[88:91], v[12:15]
    s_waitcnt vmcnt(4)
    buffer_load_dwordx4 v[88:91], v4, s[32:35], s72 offen nt
    s_add_u32 s72, s72, 1024
    v_and_b32_dpp v24, v125, v120 row_newbcast:0 row_mask:0xf bank_mask:0xf
    v_and_b32_dpp v25, v125, v121 row_newbcast:0 row_mask:0xf bank_mask:0xf
    v_and_b32_dpp v26, v125, v122 row_newbcast:0 row_mask:0xf bank_mask:0xf
    v_and_b32_dpp v27, v125, v123 row_newbcast:0 row_mask:0xf bank_mask:0xf
    v_mov_b32 v124, v125
    v_mfma_f32_16x16x32_bf16 v[12:15], v[28:31], v[92:95], v[12:15]
    s_waitcnt vmcnt(4)
    buffer_load_dwordx4 v[92:95], v4, s[32:35], s72 offen nt
    s_add_u32 s72, s72, 3666944
    s_nop 4
    s_branch L_v3_end
L_v3_2:
    v_add_u32 v224, 256, v224
    ds_read_b32 v125, v224
    v_and_b32_dpp v28, v124, v120 row_newbcast:8 row_mask:0xf bank_mask:0xf
    v_and_b32_dpp v29, v124, v121 row_newbcast:8 row_mask:0xf bank_mask:0xf
    v_and_b32_dpp v30, v124, v122 row_newbcast:8 row_mask:0xf bank_mask:0xf
    v_and_b32_dpp v31, v124, v123 row_newbcast:8 row_mask:0xf bank_mask:0xf
    v_mfma_f32_16x16x32_bf16 v[12:15], v[24:27], v[32:35], v[12:15]
    s_waitcnt vmcnt(5)
    buffer_load_dwordx4 v[32:35], v4, s[32:35], s72 offen nt
    s_add_u32 s72, s72, 1024
    v_and_b32_dpp v24, v124, v120 row_newbcast:4 row_mask:0xf bank_mask:0xf
    v_and_b32_dpp v25, v124, v121 row_newbcast:4 row_mask:0xf bank_mask:0xf
    v_and_b32_dpp v26, v124, v122 row_newbcast:4 row_mask:0xf bank_mask:0xf
    v_and_b32_dpp v27, v124, v123 row_newbcast:4 row_mask:0xf bank_mask:0xf
    v_mfma_f32_16x16x32_bf16 v[12:15], v[28:31], v[36:39], v[12:15]
    s_waitcnt vmcnt(5)
    buffer_load_dwordx4 v[36:39], v4, s[32:35], s72 offen nt
    s_add_u32 s72, s72, 1024
    v_and_b32_dpp v28, v124, v120 row_newbcast:12 row_mask:0xf bank_mask:0xf
    v_and_b32_dpp v29, v124, v121 row_newbcast:12 row_mask:0xf bank_mask:0xf
    v_and_b32_dpp v30, v124, v122 row_newbcast:12 row_mask:0xf bank_mask:0xf
    v_and_b32_dpp v31, v124, v123 row_newbcast:12 row_mask:0xf bank_mask:0xf
    v_mfma_f32_16x16x32_bf16 v[12:15], v[24:27], v[40:43], v[12:15]
    s_waitcnt vmcnt(5)
    buffer_load_dwordx4 v[40:43], v4, s[32:35], s72 offen nt
    s_add_u32 s72, s72, 1024
    v_and_b32_dpp v24, v124, v120 row_newbcast:2 row_mask:0xf bank_mask:0xf
    v_and_b32_dpp v25, v124, v121 row_newbcast:2 row_mask:0xf bank_mask:0xf
    v_and_b32_dpp v26, v124, v122 row_newbcast:2 row_mask:0xf bank_mask:0xf
    v_and_b32_dpp v27, v124, v123 row_newbcast:2 row_mask:0xf bank_mask:0xf
    v_mfma_f32_16x16x32_bf16 v[12:15], v[28:31], v[44:47], v[12:15]
    s_waitcnt vmcnt(5)
    buffer_load_dwordx4 v[44:47], v4, s[32:35], s72 offen nt
    s_add_u32 s72, s72, 521216
    v_and_b32_dpp v28, v124, v120 row_newbcast:10 row_mask:0xf bank_mask:0xf
    v_and_b32_dpp v29, v124, v121 row_newbcast:10 row_mask:0xf bank_mask:0xf
    v_and_b32_dpp v30, v124, v122 row_newbcast:10 row_mask:0xf bank_mask:0xf
    v_and_b32_dpp v31, v124, v123 row_newbcast:10 row_mask:0xf bank_mask:0xf
    v_mfma_f32_16x16x32_bf16 v[12:15], v[24:27], v[48:51], v[12:15]
    s_waitcnt vmcnt(5)
    buffer_load_dwordx4 v[48:51], v4, s[32:35], s72 offen nt
    s_add_u32 s72, s72, 1024
    v_and_b32_dpp v24, v124, v120 row_newbcast:6 row_mask:0xf bank_mask:0xf
    v_and_b32_dpp v25, v124, v121 row_newbcast:6 row_mask:0xf bank_mask:0xf
    v_and_b32_dpp v26, v124, v122 row_newbcast:6 row_mask:0xf bank_mask:0xf
    v_and_b32_dpp v27, v124, v123 row_newbcast:6 row_mask:0xf bank_mask:0xf
    v_mfma_f32_16x16x32_bf16 v[12:15], v[28:31], v[52:55], v[12:15]
    s_waitcnt vmcnt(5)
    buffer_load_dwordx4 v[52:55], v4, s[32:35], s72 offen nt
    s_add_u32 s72, s72, 1024
    s_waitcnt lgkmcnt(0)
    v_sub_f32 v125, v125, v226
    v_mul_f32 v125, s76, v125
    v_exp_f32 v125, v125
    s_nop 0
    v_add_f32 v127, v127, v125
    v_cvt_pk_bf16_f32 v125, v125, v125
    v_and_b32_dpp v28, v124, v120 row_newbcast:14 row_mask:0xf bank_mask:0xf
    v_and_b32_dpp v29, v124, v121 row_newbcast:14 row_mask:0xf bank_mask:0xf
    v_and_b32_dpp v30, v124, v122 row_newbcast:14 row_mask:0xf bank_mask:0xf
    v_and_b32_dpp v31, v124, v123 row_newbcast:14 row_mask:0xf bank_mask:0xf
    v_mfma_f32_16x16x32_bf16 v[12:15], v[24:27], v[56:59], v[12:15]
    s_waitcnt vmcnt(5)
    buffer_load_dwordx4 v[56:59], v4, s[32:35], s72 offen nt
    s_add_u32 s72, s72, 1024
    s_memrealtime s[64:65]
    ds_read_b64 v[242:243], v247 offset:46416
    v_and_b32_dpp v24, v124, v120 row_newbcast:1 row_mask:0xf bank_mask:0xf
    v_and_b32_dpp v25, v124, v121 row_newbcast:1 row_mask:0xf bank_mask:0xf
    v_and_b32_dpp v26, v124, v122 row_newbcast:1 row_mask:0xf bank_mask:0xf
    v_and_b32_dpp v27, v124, v123 row_newbcast:1 row_mask:0xf bank_mask:0xf
    v_mfma_f32_16x16x32_bf16 v[12:15], v[28:31], v[60:63], v[12:15]
    s_waitcnt vmcnt(5)
    buffer_load_dwordx4 v[60:63], v4, s[32:35], s72 offen nt
    s_add_u32 s72, s72, 3666944
    v_and_b32_dpp v28, v124, v120 row_newbcast:9 row_mask:0xf bank_mask:0xf
    v_and_b32_dpp v29, v124, v121 row_newbcast:9 row_mask:0xf bank_mask:0xf
    v_and_b32_dpp v30, v124, v122 row_newbcast:9 row_mask:0xf bank_mask:0xf
    v_and_b32_dpp v31, v124, v123 row_newbcast:9 row_mask:0xf bank_mask:0xf
    v_mfma_f32_16x16x32_bf16 v[12:15], v[24:27], v[64:67], v[12:15]
    s_waitcnt vmcnt(5)
    buffer_load_dwordx4 v[64:67], v4, s[32:35], s72 offen nt
    s_add_u32 s72, s72, 1024
    v_and_b32_dpp v24, v124, v120 row_newbcast:5 row_mask:0xf bank_mask:0xf
    v_and_b32_dpp v25, v124, v121 row_newbcast:5 row_mask:0xf bank_mask:0xf
    v_and_b32_dpp v26, v124, v122 row_newbcast:5 row_mask:0xf bank_mask:0xf
    v_and_b32_dpp v27, v124, v123 row_newbcast:5 row_mask:0xf bank_mask:0xf
    v_mfma_f32_16x16x32_bf16 v[12:15], v[28:31], v[68:71], v[12:15]
    s_waitcnt vmcnt(5)
    buffer_load_dwordx4 v[68:71], v4, s[32:35], s72 offen nt
    s_add_u32 s72, s72, 1024
    v_and_b32_dpp v28, v124, v120 row_newbcast:13 row_mask:0xf bank_mask:0xf
    v_and_b32_dpp v29, v124, v121 row_newbcast:13 row_mask:0xf bank_mask:0xf
    v_and_b32_dpp v30, v124, v122 row_newbcast:13 row_mask:0xf bank_mask:0xf
    v_and_b32_dpp v31, v124, v123 row_newbcast:13 row_mask:0xf bank_mask:0xf
    v_mfma_f32_16x16x32_bf16 v[12:15], v[24:27], v[72:75], v[12:15]
    s_waitcnt vmcnt(5)
    buffer_load_dwordx4 v[72:75], v4, s[32:35], s72 offen nt
    s_add_u32 s72, s72, 1024
    v_and_b32_dpp v24, v124, v120 row_newbcast:3 row_mask:0xf bank_mask:0xf
    v_and_b32_dpp v25, v124, v121 row_newbcast:3 row_mask:0xf bank_mask:0xf
    v_and_b32_dpp v26, v124, v122 row_newbcast:3 row_mask:0xf bank_mask:0xf
    v_and_b32_dpp v27, v124, v123 row_newbcast:3 row_mask:0xf bank_mask:0xf
    v_mfma_f32_16x16x32_bf16 v[12:15], v[28:31], v[76:79], v[12:15]
    s_waitcnt vmcnt(5)
    buffer_load_dwordx4 v[76:79], v4, s[32:35], s72 offen nt
    s_add_u32 s72, s72, 521216
    s_waitcnt lgkmcnt(0)
    v_readfirstlane_b32 s62, v242
    v_readfirstlane_b32 s63, v243
    s_sub_u32 s68, s64, s69
    s_add_u32 s69, s69, 216
    s_add_u32 s67, s67, 1
    v_mov_b32 v244, s68
    v_mov_b32 v245, s67
    ds_write_b64 v246, v[244:245] offset:46432
    s_sub_u32 s68, s68, s62
    s_and_b32 s68, s68, s63
    s_mov_b32 s70, 0
    s_cmp_gt_i32 s68, -60
    s_addc_u32 s70, s70, 0
    s_cmp_gt_i32 s68, 25
    s_addc_u32 s70, s70, 0
    s_cmp_gt_i32 s68, 90
    s_addc_u32 s70, s70, 0
    v_and_b32_dpp v28, v124, v120 row_newbcast:11 row_mask:0xf bank_mask:0xf
    v_and_b32_dpp v29, v124, v121 row_newbcast:11 row_mask:0xf bank_mask:0xf
    v_and_b32_dpp v30, v124, v122 row_newbcast:11 row_mask:0xf bank_mask:0xf
    v_and_b32_dpp v31, v124, v123 row_newbcast:11 row_mask:0xf bank_mask:0xf
    v_mfma_f32_16x16x32_bf16 v[12:15], v[24:27], v[80:83], v[12:15]
    s_waitcnt vmcnt(5)
    buffer_load_dwordx4 v[80:83], v4, s[32:35], s72 offen nt
    s_add_u32 s72, s72, 1024
    v_and_b32_dpp v24, v124, v120 row_newbcast:7 row_mask:0xf bank_mask:0xf
    v_and_b32_dpp v25, v124, v121 row_newbcast:7 row_mask:0xf bank_mask:0xf
    v_and_b32_dpp v26, v124, v122 row_newbcast:7 row_mask:0xf bank_mask:0xf
    v_and_b32_dpp v27, v124, v123 row_newbcast:7 row_mask:0xf bank_mask:0xf
    v_mfma_f32_16x16x32_bf16 v[12:15], v[28:31], v[84:87], v[12:15]
    s_waitcnt vmcnt(5)
    buffer_load_dwordx4 v[84:87], v4, s[32:35], s72 offen nt
    s_add_u32 s72, s72, 1024
    v_and_b32_dpp v28, v124, v120 row_newbcast:15 row_mask:0xf bank_mask:0xf
    v_and_b32_dpp v29, v124, v121 row_newbcast:15 row_mask:0xf bank_mask:0xf
    v_and_b32_dpp v30, v124, v122 row_newbcast:15 row_mask:0xf bank_mask:0xf
    v_and_b32_dpp v31, v124, v123 row_newbcast:15 row_mask:0xf bank_mask:0xf
    v_mfma_f32_16x16x32_bf16 v[12:15], v[24:27], v[88:91], v[12:15]
    s_waitcnt vmcnt(5)
    buffer_load_dwordx4 v[88:91], v4, s[32:35], s72 offen nt
    s_add_u32 s72, s72, 1024
    v_and_b32_dpp v24, v125, v120 row_newbcast:0 row_mask:0xf bank_mask:0xf
    v_and_b32_dpp v25, v125, v121 row_newbcast:0 row_mask:0xf bank_mask:0xf
    v_and_b32_dpp v26, v125, v122 row_newbcast:0 row_mask:0xf bank_mask:0xf
    v_and_b32_dpp v27, v125, v123 row_newbcast:0 row_mask:0xf bank_mask:0xf
    v_mov_b32 v124, v125
    v_mfma_f32_16x16x32_bf16 v[12:15], v[28:31], v[92:95], v[12:15]
    s_waitcnt vmcnt(5)
    buffer_load_dwordx4 v[92:95], v4, s[32:35], s72 offen nt
    s_add_u32 s72, s72, 3666944
    s_nop 4
    s_branch L_v3_end
L_v3_3:
    v_add_u32 v224, 256, v224
    ds_read_b32 v125, v224
    v_and_b32_dpp v28, v124, v120 row_newbcast:8 row_mask:0xf bank_mask:0xf
    v_and_b32_dpp v29, v124, v121 row_newbcast:8 row_mask:0xf bank_mask:0xf
    v_and_b32_dpp v30, v124, v122 row_newbcast:8 row_mask:0xf bank_mask:0xf
    v_and_b32_dpp v31, v124, v123 row_newbcast:8 row_mask:0xf bank_mask:0xf
    v_mfma_f32_16x16x32_bf16 v[12:15], v[24:27], v[32:35], v[12:15]
    s_waitcnt vmcnt(6)
    buffer_load_dwordx4 v[32:35], v4, s[32:35], s72 offen nt
    s_add_u32 s72, s72, 1024
    v_and_b32_dpp v24, v124, v120 row_newbcast:4 row_mask:0xf bank_mask:0xf
    v_and_b32_dpp v25, v124, v121 row_newbcast:4 row_mask:0xf bank_mask:0xf
    v_and_b32_dpp v26, v124, v122 row_newbcast:4 row_mask:0xf bank_mask:0xf
    v_and_b32_dpp v27, v124, v123 row_newbcast:4 row_mask:0xf bank_mask:0xf
    v_mfma_f32_16x16x32_bf16 v[12:15], v[28:31], v[36:39], v[12:15]
    s_waitcnt vmcnt(6)
    buffer_load_dwordx4 v[36:39], v4, s[32:35], s72 offen nt
    s_add_u32 s72, s72, 1024
    v_and_b32_dpp v28, v124, v120 row_newbcast:12 row_mask:0xf bank_mask:0xf
    v_and_b32_dpp v29, v124, v121 row_newbcast:12 row_mask:0xf bank_mask:0xf
    v_and_b32_dpp v30, v124, v122 row_newbcast:12 row_mask:0xf bank_mask:0xf
    v_and_b32_dpp v31, v124, v123 row_newbcast:12 row_mask:0xf bank_mask:0xf
    v_mfma_f32_16x16x32_bf16 v[12:15], v[24:27], v[40:43], v[12:15]
    s_waitcnt vmcnt(6)
    buffer_load_dwordx4 v[40:43], v4, s[32:35], s72 offen nt
    s_add_u32 s72, s72, 1024
    v_and_b32_dpp v24, v124, v120 row_newbcast:2 row_mask:0xf bank_mask:0xf
    v_and_b32_dpp v25, v124, v121 row_newbcast:2 row_mask:0xf bank_mask:0xf
    v_and_b32_dpp v26, v124, v122 row_newbcast:2 row_mask:0xf bank_mask:0xf
    v_and_b32_dpp v27, v124, v123 row_newbcast:2 row_mask:0xf bank_mask:0xf
    v_mfma_f32_16x16x32_bf16 v[12:15], v[28:31], v[44:47], v[12:15]
    s_waitcnt vmcnt(6)
    buffer_load_dwordx4 v[44:47], v4, s[32:35], s72 offen nt
    s_add_u32 s72, s72, 521216
    v_and_b32_dpp v28, v124, v120 row_newbcast:10 row_mask:0xf bank_mask:0xf
    v_and_b32_dpp v29, v124, v121 row_newbcast:10 row_mask:0xf bank_mask:0xf
    v_and_b32_dpp v30, v124, v122 row_newbcast:10 row_mask:0xf bank_mask:0xf
    v_and_b32_dpp v31, v124, v123 row_newbcast:10 row_mask:0xf bank_mask:0xf
    v_mfma_f32_16x16x32_bf16 v[12:15], v[24:27], v[48:51], v[12:15]
    s_waitcnt vmcnt(6)
    buffer_load_dwordx4 v[48:51], v4, s[32:35], s72 offen nt
    s_add_u32 s72, s72, 1024
    v_and_b32_dpp v24, v124, v120 row_newbcast:6 row_mask:0xf bank_mask:0xf
    v_and_b32_dpp v25, v124, v121 row_newbcast:6 row_mask:0xf bank_mask:0xf
    v_and_b32_dpp v26, v124, v122 row_newbcast:6 row_mask:0xf bank_mask:0xf
    v_and_b32_dpp v27, v124, v123 row_newbcast:6 row_mask:0xf bank_mask:0xf
    v_mfma_f32_16x16x32_bf16 v[12:15], v[28:31], v[52:55], v[12:15]
    s_waitcnt vmcnt(6)
    buffer_load_dwordx4 v[52:55], v4, s[32:35], s72 offen nt
    s_add_u32 s72, s72, 1024
    s_waitcnt lgkmcnt(0)
    v_sub_f32 v125, v125, v226
    v_mul_f32 v125, s76, v125
    v_exp_f32 v125, v125
    s_nop 0
    v_add_f32 v127, v127, v125
    v_cvt_pk_bf16_f32 v125, v125, v125
    v_and_b32_dpp v28, v124, v120 row_newbcast:14 row_mask:0xf bank_mask:0xf
    v_and_b32_dpp v29, v124, v121 row_newbcast:14 row_mask:0xf bank_mask:0xf
    v_and_b32_dpp v30, v124, v122 row_newbcast:14 row_mask:0xf bank_mask:0xf
    v_and_b32_dpp v31, v124, v123 row_newbcast:14 row_mask:0xf bank_mask:0xf
    v_mfma_f32_16x16x32_bf16 v[12:15], v[24:27], v[56:59], v[12:15]
    s_waitcnt vmcnt(6)
    buffer_load_dwordx4 v[56:59], v4, s[32:35], s72 offen nt
    s_add_u32 s72, s72, 1024
    s_memrealtime s[64:65]
    ds_read_b64 v[242:243], v247 offset:46416
    v_and_b32_dpp v24, v124, v120 row_newbcast:1 row_mask:0xf bank_mask:0xf
    v_and_b32_dpp v25, v124, v121 row_newbcast:1 row_mask:0xf bank_mask:0xf
    v_and_b32_dpp v26, v124, v122 row_newbcast:1 row_mask:0xf bank_mask:0xf
    v_and_b32_dpp v27, v124, v123 row_newbcast:1 row_mask:0xf bank_mask:0xf
    v_mfma_f32_16x16x32_bf16 v[12:15], v[28:31], v[60:63], v[12:15]
    s_waitcnt vmcnt(6)
    buffer_load_dwordx4 v[60:63], v4, s[32:35], s72 offen nt
    s_add_u32 s72, s72, 3666944
    v_and_b32_dpp v28, v124, v120 row_newbcast:9 row_mask:0xf bank_mask:0xf
    v_and_b32_dpp v29, v124, v121 row_newbcast:9 row_mask:0xf bank_mask:0xf
    v_and_b32_dpp v30, v124, v122 row_newbcast:9 row_mask:0xf bank_mask:0xf
    v_and_b32_dpp v31, v124, v123 row_newbcast:9 row_mask:0xf bank_mask:0xf
    v_mfma_f32_16x16x32_bf16 v[12:15], v[24:27], v[64:67], v[12:15]
    s_waitcnt vmcnt(6)
    buffer_load_dwordx4 v[64:67], v4, s[32:35], s72 offen nt
    s_add_u32 s72, s72, 1024
    v_and_b32_dpp v24, v124, v120 row_newbcast:5 row_mask:0xf bank_mask:0xf
    v_and_b32_dpp v25, v124, v121 row_newbcast:5 row_mask:0xf bank_mask:0xf
    v_and_b32_dpp v26, v124, v122 row_newbcast:5 row_mask:0xf bank_mask:0xf
    v_and_b32_dpp v27, v124, v123 row_newbcast:5 row_mask:0xf bank_mask:0xf
    v_mfma_f32_16x16x32_bf16 v[12:15], v[28:31], v[68:71], v[12:15]
    s_waitcnt vmcnt(6)
    buffer_load_dwordx4 v[68:71], v4, s[32:35], s72 offen nt
    s_add_u32 s72, s72, 1024
    v_and_b32_dpp v28, v124, v120 row_newbcast:13 row_mask:0xf bank_mask:0xf
    v_and_b32_dpp v29, v124, v121 row_newbcast:13 row_mask:0xf bank_mask:0xf
    v_and_b32_dpp v30, v124, v122 row_newbcast:13 row_mask:0xf bank_mask:0xf
    v_and_b32_dpp v31, v124, v123 row_newbcast:13 row_mask:0xf bank_mask:0xf
    v_mfma_f32_16x16x32_bf16 v[12:15], v[24:27], v[72:75], v[12:15]
    s_waitcnt vmcnt(6)
    buffer_load_dwordx4 v[72:75], v4, s[32:35], s72 offen nt
    s_add_u32 s72, s72, 1024
    v_and_b32_dpp v24, v124, v120 row_newbcast:3 row_mask:0xf bank_mask:0xf
    v_and_b32_dpp v25, v124, v121 row_newbcast:3 row_mask:0xf bank_mask:0xf
    v_and_b32_dpp v26, v124, v122 row_newbcast:3 row_mask:0xf bank_mask:0xf
    v_and_b32_dpp v27, v124, v123 row_newbcast:3 row_mask:0xf bank_mask:0xf
    v_mfma_f32_16x16x32_bf16 v[12:15], v[28:31], v[76:79], v[12:15]
    s_waitcnt vmcnt(6)
    buffer_load_dwordx4 v[76:79], v4, s[32:35], s72 offen nt
    s_add_u32 s72, s72, 521216
    s_waitcnt lgkmcnt(0)
    v_readfirstlane_b32 s62, v242
    v_readfirstlane_b32 s63, v243
    s_sub_u32 s68, s64, s69
    s_add_u32 s69, s69, 216
    s_add_u32 s67, s67, 1
    v_mov_b32 v244, s68
    v_mov_b32 v245, s67
    ds_write_b64 v246, v[244:245] offset:46432
    s_sub_u32 s68, s68, s62
    s_and_b32 s68, s68, s63
    s_mov_b32 s70, 0
    s_cmp_gt_i32 s68, -60
    s_addc_u32 s70, s70, 0
    s_cmp_gt_i32 s68, 25
    s_addc_u32 s70, s70, 0
    s_cmp_gt_i32 s68, 90
    s_addc_u32 s70, s70, 0
    v_and_b32_dpp v28, v124, v120 row_newbcast:11 row_mask:0xf bank_mask:0xf
    v_and_b32_dpp v29, v124, v121 row_newbcast:11 row_mask:0xf bank_mask:0xf
    v_and_b32_dpp v30, v124, v122 row_newbcast:11 row_mask:0xf bank_mask:0xf
    v_and_b32_dpp v31, v124, v123 row_newbcast:11 row_mask:0xf bank_mask:0xf
    v_mfma_f32_16x16x32_bf16 v[12:15], v[24:27], v[80:83], v[12:15]
    s_waitcnt vmcnt(6)
    buffer_load_dwordx4 v[80:83], v4, s[32:35], s72 offen nt
    s_add_u32 s72, s72, 1024
    v_and_b32_dpp v24, v124, v120 row_newbcast:7 row_mask:0xf bank_mask:0xf
    v_and_b32_dpp v25, v124, v121 row_newbcast:7 row_mask:0xf bank_mask:0xf
    v_and_b32_dpp v26, v124, v122 row_newbcast:7 row_mask:0xf bank_mask:0xf
    v_and_b32_dpp v27, v124, v123 row_newbcast:7 row_mask:0xf bank_mask:0xf
    v_mfma_f32_16x16x32_bf16 v[12:15], v[28:31], v[84:87], v[12:15]
    s_waitcnt vmcnt(6)
    buffer_load_dwordx4 v[84:87], v4, s[32:35], s72 offen nt
    s_add_u32 s72, s72, 1024
    v_and_b32_dpp v28, v124, v120 row_newbcast:15 row_mask:0xf bank_mask:0xf
    v_and_b32_dpp v29, v124, v121 row_newbcast:15 row_mask:0xf bank_mask:0xf
    v_and_b32_dpp v30, v124, v122 row_newbcast:15 row_mask:0xf bank_mask:0xf
    v_and_b32_dpp v31, v124, v123 row_newbcast:15 row_mask:0xf bank_mask:0xf
    v_mfma_f32_16x16x32_bf16 v[12:15], v[24:27], v[88:91], v[12:15]
    s_waitcnt vmcnt(6)
    buffer_load_dwordx4 v[88:91], v4, s[32:35], s72 offen nt
    s_add_u32 s72, s72, 1024
    v_and_b32_dpp v24, v125, v120 row_newbcast:0 row_mask:0xf bank_mask:0xf
    v_and_b32_dpp v25, v125, v121 row_newbcast:0 row_mask:0xf bank_mask:0xf
    v_and_b32_dpp v26, v125, v122 row_newbcast:0 row_mask:0xf bank_mask:0xf
    v_and_b32_dpp v27, v125, v123 row_newbcast:0 row_mask:0xf bank_mask:0xf
    v_mov_b32 v124, v125
    v_mfma_f32_16x16x32_bf16 v[12:15], v[28:31], v[92:95], v[12:15]
    s_waitcnt vmcnt(6)
    buffer_load_dwordx4 v[92:95], v4, s[32:35], s72 offen nt
    s_add_u32 s72, s72, 3666944
    s_nop 4
L_v3_end:
    s_cmp_eq_u32 s70, 1
    s_cbranch_scc1 L_v4_1
    s_cmp_eq_u32 s70, 2
    s_cbranch_scc1 L_v4_2
    s_cmp_eq_u32 s70, 3
    s_cbranch_scc1 L_v4_3
    v_add_u32 v224, 256, v224
    ds_read_b32 v125, v224
    v_and_b32_dpp v28, v124, v120 row_newbcast:8 row_mask:0xf bank_mask:0xf
    v_and_b32_dpp v29, v124, v121 row_newbcast:8 row_mask:0xf bank_mask:0xf
    v_and_b32_dpp v30, v124, v122 row_newbcast:8 row_mask:0xf bank_mask:0xf
    v_and_b32_dpp v31, v124, v123 row_newbcast:8 row_mask:0xf bank_mask:0xf
    v_mfma_f32_16x16x32_bf16 v[12:15], v[24:27], v[128:131], v[12:15]
    s_waitcnt vmcnt(3)
    buffer_load_dwordx4 v[128:131], v4, s[32:35], s72 offen nt
    s_add_u32 s72, s72, 1024
    v_and_b32_dpp v24, v124, v120 row_newbcast:4 row_mask:0xf bank_mask:0xf
    v_and_b32_dpp v25, v124, v121 row_newbcast:4 row_mask:0xf bank_mask:0xf
    v_and_b32_dpp v26, v124, v122 row_newbcast:4 row_mask:0xf bank_mask:0xf
    v_and_b32_dpp v27, v124, v123 row_newbcast:4 row_mask:0xf bank_mask:0xf
    v_mfma_f32_16x16x32_bf16 v[12:15], v[28:31], v[132:135], v[12:15]
    s_waitcnt vmcnt(3)
    buffer_load_dwordx4 v[132:135], v4, s[32:35], s72 offen nt
    s_add_u32 s72, s72, 1024
    v_and_b32_dpp v28, v124, v120 row_newbcast:12 row_mask:0xf bank_mask:0xf
    v_and_b32_dpp v29, v124, v121 row_newbcast:12 row_mask:0xf bank_mask:0xf
    v_and_b32_dpp v30, v124, v122 row_newbcast:12 row_mask:0xf bank_mask:0xf
    v_and_b32_dpp v31, v124, v123 row_newbcast:12 row_mask:0xf bank_mask:0xf
    v_mfma_f32_16x16x32_bf16 v[12:15], v[24:27], v[136:139], v[12:15]
    s_waitcnt vmcnt(3)
    buffer_load_dwordx4 v[136:139], v4, s[32:35], s72 offen nt
    s_add_u32 s72, s72, 1024
    v_and_b32_dpp v24, v124, v120 row_newbcast:2 row_mask:0xf bank_mask:0xf
    v_and_b32_dpp v25, v124, v121 row_newbcast:2 row_mask:0xf bank_mask:0xf
    v_and_b32_dpp v26, v124, v122 row_newbcast:2 row_mask:0xf bank_mask:0xf
    v_and_b32_dpp v27, v124, v123 row_newbcast:2 row_mask:0xf bank_mask:0xf
    v_mfma_f32_16x16x32_bf16 v[12:15], v[28:31], v[140:143], v[12:15]
    s_waitcnt vmcnt(3)
    buffer_load_dwordx4 v[140:143], v4, s[32:35], s72 offen nt
    s_add_u32 s72, s72, 521216
    v_and_b32_dpp v28, v124, v120 row_newbcast:10 row_mask:0xf bank_mask:0xf
    v_and_b32_dpp v29, v124, v121 row_newbcast:10 row_mask:0xf bank_mask:0xf
    v_and_b32_dpp v30, v124, v122 row_newbcast:10 row_mask:0xf bank_mask:0xf
    v_and_b32_dpp v31, v124, v123 row_newbcast:10 row_mask:0xf bank_mask:0xf
    v_mfma_f32_16x16x32_bf16 v[12:15], v[24:27], v[144:147], v[12:15]
    s_waitcnt vmcnt(3)
    buffer_load_dwordx4 v[144:147], v4, s[32:35], s72 offen nt
    s_add_u32 s72, s72, 1024
    v_and_b32_dpp v24, v124, v120 row_newbcast:6 row_mask:0xf bank_mask:0xf
    v_and_b32_dpp v25, v124, v121 row_newbcast:6 row_mask:0xf bank_mask:0xf
    v_and_b32_dpp v26, v124, v122 row_newbcast:6 row_mask:0xf bank_mask:0xf
    v_and_b32_dpp v27, v124, v123 row_newbcast:6 row_mask:0xf bank_mask:0xf
    v_mfma_f32_16x16x32_bf16 v[12:15], v[28:31], v[148:151], v[12:15]
    s_waitcnt vmcnt(3)
    buffer_load_dwordx4 v[148:151], v4, s[32:35], s72 offen nt
    s_add_u32 s72, s72, 1024
    s_waitcnt lgkmcnt(0)
    v_sub_f32 v125, v125, v226
    v_mul_f32 v125, s76, v125
    v_exp_f32 v125, v125
    s_nop 0
    v_add_f32 v127, v127, v125
    v_cvt_pk_bf16_f32 v125, v125, v125
    v_and_b32_dpp v28, v124, v120 row_newbcast:14 row_mask:0xf bank_mask:0xf
    v_and_b32_dpp v29, v124, v121 row_newbcast:14 row_mask:0xf bank_mask:0xf
    v_and_b32_dpp v30, v124, v122 row_newbcast:14 row_mask:0xf bank_mask:0xf
    v_and_b32_dpp v31, v124, v123 row_newbcast:14 row_mask:0xf bank_mask:0xf
    v_mfma_f32_16x16x32_bf16 v[12:15], v[24:27], v[152:155], v[12:15]
    s_waitcnt vmcnt(3)
    buffer_load_dwordx4 v[152:155], v4, s[32:35], s72 offen nt
    s_add_u32 s72, s72, 1024
    s_memrealtime s[64:65]
    ds_read_b64 v[242:243], v247 offset:46416
    v_and_b32_dpp v24, v124, v120 row_newbcast:1 row_mask:0xf bank_mask:0xf
    v_and_b32_dpp v25, v124, v121 row_newbcast:1 row_mask:0xf bank_mask:0xf
    v_and_b32_dpp v26, v124, v122 row_newbcast:1 row_mask:0xf bank_mask:0xf
    v_and_b32_dpp v27, v124, v123 row_newbcast:1 row_mask:0xf bank_mask:0xf
    v_mfma_f32_16x16x32_bf16 v[12:15], v[28:31], v[156:159], v[12:15]
    s_waitcnt vmcnt(3)
    buffer_load_dwordx4 v[156:159], v4, s[32:35], s72 offen nt
    s_add_u32 s72, s72, 3666944
    v_and_b32_dpp v28, v124, v120 row_newbcast:9 row_mask:0xf bank_mask:0xf
    v_and_b32_dpp v29, v124, v121 row_newbcast:9 row_mask:0xf bank_mask:0xf
    v_and_b32_dpp v30, v124, v122 row_newbcast:9 row_mask:0xf bank_mask:0xf
    v_and_b32_dpp v31, v124, v123 row_newbcast:9 row_mask:0xf bank_mask:0xf
    v_mfma_f32_16x16x32_bf16 v[12:15], v[24:27], v[160:163], v[12:15]
    s_waitcnt vmcnt(3)
    buffer_load_dwordx4 v[160:163], v4, s[32:35], s72 offen nt
    s_add_u32 s72, s72, 1024
    v_and_b32_dpp v24, v124, v120 row_newbcast:5 row_mask:0xf bank_mask:0xf
    v_and_b32_dpp v25, v124, v121 row_newbcast:5 row_mask:0xf bank_mask:0xf
    v_and_b32_dpp v26, v124, v122 row_newbcast:5 row_mask:0xf bank_mask:0xf
    v_and_b32_dpp v27, v124, v123 row_newbcast:5 row_mask:0xf bank_mask:0xf
    v_mfma_f32_16x16x32_bf16 v[12:15], v[28:31], v[164:167], v[12:15]
    s_waitcnt vmcnt(3)
    buffer_load_dwordx4 v[164:167], v4, s[32:35], s72 offen nt
    s_add_u32 s72, s72, 1024
    v_and_b32_dpp v28, v124, v120 row_newbcast:13 row_mask:0xf bank_mask:0xf
    v_and_b32_dpp v29, v124, v121 row_newbcast:13 row_mask:0xf bank_mask:0xf
    v_and_b32_dpp v30, v124, v122 row_newbcast:13 row_mask:0xf bank_mask:0xf
    v_and_b32_dpp v31, v124, v123 row_newbcast:13 row_mask:0xf bank_mask:0xf
    v_mfma_f32_16x16x32_bf16 v[12:15], v[24:27], v[168:171], v[12:15]
    s_waitcnt vmcnt(3)
    buffer_load_dwordx4 v[168:171], v4, s[32:35], s72 offen nt
    s_add_u32 s72, s72, 1024
    v_and_b32_dpp v24, v124, v120 row_newbcast:3 row_mask:0xf bank_mask:0xf
    v_and_b32_dpp v25, v124, v121 row_newbcast:3 row_mask:0xf bank_mask:0xf
    v_and_b32_dpp v26, v124, v122 row_newbcast:3 row_mask:0xf bank_mask:0xf
    v_and_b32_dpp v27, v124, v123 row_newbcast:3 row_mask:0xf bank_mask:0xf
    v_mfma_f32_16x16x32_bf16 v[12:15], v[28:31], v[172:175], v[12:15]
    s_waitcnt vmcnt(3)
    buffer_load_dwordx4 v[172:175], v4, s[32:35], s72 offen nt
    s_add_u32 s72, s72, 521216
    s_waitcnt lgkmcnt(0)
    v_readfirstlane_b32 s62, v242
    v_readfirstlane_b32 s63, v243
    s_sub_u32 s68, s64, s69
    s_add_u32 s69, s69, 216
    s_add_u32 s67, s67, 1
    v_mov_b32 v244, s68
    v_mov_b32 v245, s67
    ds_write_b64 v246, v[244:245] offset:46432
    s_sub_u32 s68, s68, s62
    s_and_b32 s68, s68, s63
    s_mov_b32 s70, 0
    s_cmp_gt_i32 s68, -60
    s_addc_u32 s70, s70, 0
    s_cmp_gt_i32 s68, 25
    s_addc_u32 s70, s70, 0
    s_cmp_gt_i32 s68, 90
    s_addc_u32 s70, s70, 0
    v_and_b32_dpp v28, v124, v120 row_newbcast:11 row_mask:0xf bank_mask:0xf
    v_and_b32_dpp v29, v124, v121 row_newbcast:11 row_mask:0xf bank_mask:0xf
    v_and_b32_dpp v30, v124, v122 row_newbcast:11 row_mask:0xf bank_mask:0xf
    v_and_b32_dpp v31, v124, v123 row_newbcast:11 row_mask:0xf bank_mask:0xf
    v_mfma_f32_16x16x32_bf16 v[12:15], v[24:27], v[176:179], v[12:15]
    s_waitcnt vmcnt(3)
    buffer_load_dwordx4 v[176:179], v4, s[32:35], s72 offen nt
    s_add_u32 s72, s72, 1024
    v_and_b32_dpp v24, v124, v120 row_newbcast:7 row_mask:0xf bank_mask:0xf
    v_and_b32_dpp v25, v124, v121 row_newbcast:7 row_mask:0xf bank_mask:0xf
    v_and_b32_dpp v26, v124, v122 row_newbcast:7 row_mask:0xf bank_mask:0xf
    v_and_b32_dpp v27, v124, v123 row_newbcast:7 row_mask:0xf bank_mask:0xf
    v_mfma_f32_16x16x32_bf16 v[12:15], v[28:31], v[180:183], v[12:15]
    s_waitcnt vmcnt(3)
    buffer_load_dwordx4 v[180:183], v4, s[32:35], s72 offen nt
    s_add_u32 s72, s72, 1024
    v_and_b32_dpp v28, v124, v120 row_newbcast:15 row_mask:0xf bank_mask:0xf
    v_and_b32_dpp v29, v124, v121 row_newbcast:15 row_mask:0xf bank_mask:0xf
    v_and_b32_dpp v30, v124, v122 row_newbcast:15 row_mask:0xf bank_mask:0xf
    v_and_b32_dpp v31, v124, v123 row_newbcast:15 row_mask:0xf bank_mask:0xf
    v_mfma_f32_16x16x32_bf16 v[12:15], v[24:27], v[184:187], v[12:15]
    s_waitcnt vmcnt(3)
    buffer_load_dwordx4 v[184:187], v4, s[32:35], s72 offen nt
    s_add_u32 s72, s72, 1024
    v_and_b32_dpp v24, v125, v120 row_newbcast:0 row_mask:0xf bank_mask:0xf
    v_and_b32_dpp v25, v125, v121 row_newbcast:0 row_mask:0xf bank_mask:0xf
    v_and_b32_dpp v26, v125, v122 row_newbcast:0 row_mask:0xf bank_mask:0xf
    v_and_b32_dpp v27, v125, v123 row_newbcast:0 row_mask:0xf bank_mask:0xf
    v_mov_b32 v124, v125
    v_mfma_f32_16x16x32_bf16 v[12:15], v[28:31], v[188:191], v[12:15]
    s_waitcnt vmcnt(3)
    buffer_load_dwordx4 v[188:191], v4, s[32:35], s72 offen nt
    s_or_b32 s72, s72, 4291428351
    s_add_u32 s72, s72, 1
    s_and_b32 s72, s72, 3538944
    s_nop 2
    s_branch L_v4_end
L_v4_1:
    v_add_u32 v224, 256, v224
    ds_read_b32 v125, v224
    v_and_b32_dpp v28, v124, v120 row_newbcast:8 row_mask:0xf bank_mask:0xf
    v_and_b32_dpp v29, v124, v121 row_newbcast:8 row_mask:0xf bank_mask:0xf
    v_and_b32_dpp v30, v124, v122 row_newbcast:8 row_mask:0xf bank_mask:0xf
    v_and_b32_dpp v31, v124, v123 row_newbcast:8 row_mask:0xf bank_mask:0xf
    v_mfma_f32_16x16x32_bf16 v[12:15], v[24:27], v[128:131], v[12:15]
    s_waitcnt vmcnt(4)
    buffer_load_dwordx4 v[128:131], v4, s[32:35], s72 offen nt
    s_add_u32 s72, s72, 1024
    v_and_b32_dpp v24, v124, v120 row_newbcast:4 row_mask:0xf bank_mask:0xf
    v_and_b32_dpp v25, v124, v121 row_newbcast:4 row_mask:0xf bank_mask:0xf
    v_and_b32_dpp v26, v124, v122 row_newbcast:4 row_mask:0xf bank_mask:0xf
    v_and_b32_dpp v27, v124, v123 row_newbcast:4 row_mask:0xf bank_mask:0xf
    v_mfma_f32_16x16x32_bf16 v[12:15], v[28:31], v[132:135], v[12:15]
    s_waitcnt vmcnt(4)
    buffer_load_dwordx4 v[132:135], v4, s[32:35], s72 offen nt
    s_add_u32 s72, s72, 1024
    v_and_b32_dpp v28, v124, v120 row_newbcast:12 row_mask:0xf bank_mask:0xf
    v_and_b32_dpp v29, v124, v121 row_newbcast:12 row_mask:0xf bank_mask:0xf
    v_and_b32_dpp v30, v124, v122 row_newbcast:12 row_mask:0xf bank_mask:0xf
    v_and_b32_dpp v31, v124, v123 row_newbcast:12 row_mask:0xf bank_mask:0xf
    v_mfma_f32_16x16x32_bf16 v[12:15], v[24:27], v[136:139], v[12:15]
    s_waitcnt vmcnt(4)
    buffer_load_dwordx4 v[136:139], v4, s[32:35], s72 offen nt
    s_add_u32 s72, s72, 1024
    v_and_b32_dpp v24, v124, v120 row_newbcast:2 row_mask:0xf bank_mask:0xf
    v_and_b32_dpp v25, v124, v121 row_newbcast:2 row_mask:0xf bank_mask:0xf
    v_and_b32_dpp v26, v124, v122 row_newbcast:2 row_mask:0xf bank_mask:0xf
    v_and_b32_dpp v27, v124, v123 row_newbcast:2 row_mask:0xf bank_mask:0xf
    v_mfma_f32_16x16x32_bf16 v[12:15], v[28:31], v[140:143], v[12:15]
    s_waitcnt vmcnt(4)
    buffer_load_dwordx4 v[140:143], v4, s[32:35], s72 offen nt
    s_add_u32 s72, s72, 521216
    v_and_b32_dpp v28, v124, v120 row_newbcast:10 row_mask:0xf bank_mask:0xf
    v_and_b32_dpp v29, v124, v121 row_newbcast:10 row_mask:0xf bank_mask:0xf
    v_and_b32_dpp v30, v124, v122 row_newbcast:10 row_mask:0xf bank_mask:0xf
    v_and_b32_dpp v31, v124, v123 row_newbcast:10 row_mask:0xf bank_mask:0xf
    v_mfma_f32_16x16x32_bf16 v[12:15], v[24:27], v[144:147], v[12:15]
    s_waitcnt vmcnt(4)
    buffer_load_dwordx4 v[144:147], v4, s[32:35], s72 offen nt
    s_add_u32 s72, s72, 1024
    v_and_b32_dpp v24, v124, v120 row_newbcast:6 row_mask:0xf bank_mask:0xf
    v_and_b32_dpp v25, v124, v121 row_newbcast:6 row_mask:0xf bank_mask:0xf
    v_and_b32_dpp v26, v124, v122 row_newbcast:6 row_mask:0xf bank_mask:0xf
    v_and_b32_dpp v27, v124, v123 row_newbcast:6 row_mask:0xf bank_mask:0xf
    v_mfma_f32_16x16x32_bf16 v[12:15], v[28:31], v[148:151], v[12:15]
    s_waitcnt vmcnt(4)
    buffer_load_dwordx4 v[148:151], v4, s[32:35], s72 offen nt
    s_add_u32 s72, s72, 1024
    s_waitcnt lgkmcnt(0)
    v_sub_f32 v125, v125, v226
    v_mul_f32 v125, s76, v125
    v_exp_f32 v125, v125
    s_nop 0
    v_add_f32 v127, v127, v125
    v_cvt_pk_bf16_f32 v125, v125, v125
    v_and_b32_dpp v28, v124, v120 row_newbcast:14 row_mask:0xf bank_mask:0xf
    v_and_b32_dpp v29, v124, v121 row_newbcast:14 row_mask:0xf bank_mask:0xf
    v_and_b32_dpp v30, v124, v122 row_newbcast:14 row_mask:0xf bank_mask:0xf
    v_and_b32_dpp v31, v124, v123 row_newbcast:14 row_mask:0xf bank_mask:0xf
    v_mfma_f32_16x16x32_bf16 v[12:15], v[24:27], v[152:155], v[12:15]
    s_waitcnt vmcnt(4)
    buffer_load_dwordx4 v[152:155], v4, s[32:35], s72 offen nt
    s_add_u32 s72, s72, 1024
    s_memrealtime s[64:65]
    ds_read_b64 v[242:243], v247 offset:46416
    v_and_b32_dpp v24, v124, v120 row_newbcast:1 row_mask:0xf bank_mask:0xf
    v_and_b32_dpp v25, v124, v121 row_newbcast:1 row_mask:0xf bank_mask:0xf
    v_and_b32_dpp v26, v124, v122 row_newbcast:1 row_mask:0xf bank_mask:0xf
    v_and_b32_dpp v27, v124, v123 row_newbcast:1 row_mask:0xf bank_mask:0xf
    v_mfma_f32_16x16x32_bf16 v[12:15], v[28:31], v[156:159], v[12:15]
    s_waitcnt vmcnt(4)
    buffer_load_dwordx4 v[156:159], v4, s[32:35], s72 offen nt
    s_add_u32 s72, s72, 3666944
    v_and_b32_dpp v28, v124, v120 row_newbcast:9 row_mask:0xf bank_mask:0xf
    v_and_b32_dpp v29, v124, v121 row_newbcast:9 row_mask:0xf bank_mask:0xf
    v_and_b32_dpp v30, v124, v122 row_newbcast:9 row_mask:0xf bank_mask:0xf
    v_and_b32_dpp v31, v124, v123 row_newbcast:9 row_mask:0xf bank_mask:0xf
    v_mfma_f32_16x16x32_bf16 v[12:15], v[24:27], v[160:163], v[12:15]
    s_waitcnt vmcnt(4)
    buffer_load_dwordx4 v[160:163], v4, s[32:35], s72 offen nt
    s_add_u32 s72, s72, 1024
    v_and_b32_dpp v24, v124, v120 row_newbcast:5 row_mask:0xf bank_mask:0xf
    v_and_b32_dpp v25, v124, v121 row_newbcast:5 row_mask:0xf bank_mask:0xf
    v_and_b32_dpp v26, v124, v122 row_newbcast:5 row_mask:0xf bank_mask:0xf
    v_and_b32_dpp v27, v124, v123 row_newbcast:5 row_mask:0xf bank_mask:0xf
    v_mfma_f32_16x16x32_bf16 v[12:15], v[28:31], v[164:167], v[12:15]
    s_waitcnt vmcnt(4)
    buffer_load_dwordx4 v[164:167], v4, s[32:35], s72 offen nt
    s_add_u32 s72, s72, 1024
    v_and_b32_dpp v28, v124, v120 row_newbcast:13 row_mask:0xf bank_mask:0xf
    v_and_b32_dpp v29, v124, v121 row_newbcast:13 row_mask:0xf bank_mask:0xf
    v_and_b32_dpp v30, v124, v122 row_newbcast:13 row_mask:0xf bank_mask:0xf
    v_and_b32_dpp v31, v124, v123 row_newbcast:13 row_mask:0xf bank_mask:0xf
    v_mfma_f32_16x16x32_bf16 v[12:15], v[24:27], v[168:171], v[12:15]
    s_waitcnt vmcnt(4)
    buffer_load_dwordx4 v[168:171], v4, s[32:35], s72 offen nt
    s_add_u32 s72, s72, 1024
    v_and_b32_dpp v24, v124, v120 row_newbcast:3 row_mask:0xf bank_mask:0xf
    v_and_b32_dpp v25, v124, v121 row_newbcast:3 row_mask:0xf bank_mask:0xf
    v_and_b32_dpp v26, v124, v122 row_newbcast:3 row_mask:0xf bank_mask:0xf
    v_and_b32_dpp v27, v124, v123 row_newbcast:3 row_mask:0xf bank_mask:0xf
    v_mfma_f32_16x16x32_bf16 v[12:15], v[28:31], v[172:175], v[12:15]
    s_waitcnt vmcnt(4)
    buffer_load_dwordx4 v[172:175], v4, s[32:35], s72 offen nt
    s_add_u32 s72, s72, 521216
    s_waitcnt lgkmcnt(0)
    v_readfirstlane_b32 s62, v242
    v_readfirstlane_b32 s63, v243
    s_sub_u32 s68, s64, s69
    s_add_u32 s69, s69, 216
    s_add_u32 s67, s67, 1
    v_mov_b32 v244, s68
    v_mov_b32 v245, s67
    ds_write_b64 v246, v[244:245] offset:46432
    s_sub_u32 s68, s68, s62
    s_and_b32 s68, s68, s63
    s_mov_b32 s70, 0
    s_cmp_gt_i32 s68, -60
    s_addc_u32 s70, s70, 0
    s_cmp_gt_i32 s68, 25
    s_addc_u32 s70, s70, 0
    s_cmp_gt_i32 s68, 90
    s_addc_u32 s70, s70, 0
    v_and_b32_dpp v28, v124, v120 row_newbcast:11 row_mask:0xf bank_mask:0xf
    v_and_b32_dpp v29, v124, v121 row_newbcast:11 row_mask:0xf bank_mask:0xf
    v_and_b32_dpp v30, v124, v122 row_newbcast:11 row_mask:0xf bank_mask:0xf
    v_and_b32_dpp v31, v124, v123 row_newbcast:11 row_mask:0xf bank_mask:0xf
    v_mfma_f32_16x16x32_bf16 v[12:15], v[24:27], v[176:179], v[12:15]
    s_waitcnt vmcnt(4)
    buffer_load_dwordx4 v[176:179], v4, s[32:35], s72 offen nt
    s_add_u32 s72, s72, 1024
    v_and_b32_dpp v24, v124, v120 row_newbcast:7 row_mask:0xf bank_mask:0xf
    v_and_b32_dpp v25, v124, v121 row_newbcast:7 row_mask:0xf bank_mask:0xf
    v_and_b32_dpp v26, v124, v122 row_newbcast:7 row_mask:0xf bank_mask:0xf
    v_and_b32_dpp v27, v124, v123 row_newbcast:7 row_mask:0xf bank_mask:0xf
    v_mfma_f32_16x16x32_bf16 v[12:15], v[28:31], v[180:183], v[12:15]
    s_waitcnt vmcnt(4)
    buffer_load_dwordx4 v[180:183], v4, s[32:35], s72 offen nt
    s_add_u32 s72, s72, 1024
    v_and_b32_dpp v28, v124, v120 row_newbcast:15 row_mask:0xf bank_mask:0xf
    v_and_b32_dpp v29, v124, v121 row_newbcast:15 row_mask:0xf bank_mask:0xf
    v_and_b32_dpp v30, v124, v122 row_newbcast:15 row_mask:0xf bank_mask:0xf
    v_and_b32_dpp v31, v124, v123 row_newbcast:15 row_mask:0xf bank_mask:0xf
    v_mfma_f32_16x16x32_bf16 v[12:15], v[24:27], v[184:187], v[12:15]
    s_waitcnt vmcnt(4)
    buffer_load_dwordx4 v[184:187], v4, s[32:35], s72 offen nt
    s_add_u32 s72, s72, 1024
    v_and_b32_dpp v24, v125, v120 row_newbcast:0 row_mask:0xf bank_mask:0xf
    v_and_b32_dpp v25, v125, v121 row_newbcast:0 row_mask:0xf bank_mask:0xf
    v_and_b32_dpp v26, v125, v122 row_newbcast:0 row_mask:0xf bank_mask:0xf
    v_and_b32_dpp v27, v125, v123 row_newbcast:0 row_mask:0xf bank_mask:0xf
    v_mov_b32 v124, v125
    v_mfma_f32_16x16x32_bf16 v[12:15], v[28:31], v[188:191], v[12:15]
    s_waitcnt vmcnt(4)
    buffer_load_dwordx4 v[188:191], v4, s[32:35], s72 offen nt
    s_or_b32 s72, s72, 4291428351
    s_add_u32 s72, s72, 1
    s_and_b32 s72, s72, 3538944
    s_nop 2
    s_branch L_v4_end
L_v4_2:
    v_add_u32 v224, 256, v224
    ds_read_b32 v125, v224
    v_and_b32_dpp v28, v124, v120 row_newbcast:8 row_mask:0xf bank_mask:0xf
    v_and_b32_dpp v29, v124, v121 row_newbcast:8 row_mask:0xf bank_mask:0xf
    v_and_b32_dpp v30, v124, v122 row_newbcast:8 row_mask:0xf bank_mask:0xf
    v_and_b32_dpp v31, v124, v123 row_newbcast:8 row_mask:0xf bank_mask:0xf
    v_mfma_f32_16x16x32_bf16 v[12:15], v[24:27], v[128:131], v[12:15]
    s_waitcnt vmcnt(5)
    buffer_load_dwordx4 v[128:131], v4, s[32:35], s72 offen nt
    s_add_u32 s72, s72, 1024
    v_and_b32_dpp v24, v124, v120 row_newbcast:4 row_mask:0xf bank_mask:0xf
    v_and_b32_dpp v25, v124, v121 row_newbcast:4 row_mask:0xf bank_mask:0xf
    v_and_b32_dpp v26, v124, v122 row_newbcast:4 row_mask:0xf bank_mask:0xf
    v_and_b32_dpp v27, v124, v123 row_newbcast:4 row_mask:0xf bank_mask:0xf
    v_mfma_f32_16x16x32_bf16 v[12:15], v[28:31], v[132:135], v[12:15]
    s_waitcnt vmcnt(5)
    buffer_load_dwordx4 v[132:135], v4, s[32:35], s72 offen nt
    s_add_u32 s72, s72, 1024
    v_and_b32_dpp v28, v124, v120 row_newbcast:12 row_mask:0xf bank_mask:0xf
    v_and_b32_dpp v29, v124, v121 row_newbcast:12 row_mask:0xf bank_mask:0xf
    v_and_b32_dpp v30, v124, v122 row_newbcast:12 row_mask:0xf bank_mask:0xf
    v_and_b32_dpp v31, v124, v123 row_newbcast:12 row_mask:0xf bank_mask:0xf
    v_mfma_f32_16x16x32_bf16 v[12:15], v[24:27], v[136:139], v[12:15]
    s_waitcnt vmcnt(5)
    buffer_load_dwordx4 v[136:139], v4, s[32:35], s72 offen nt
    s_add_u32 s72, s72, 1024
    v_and_b32_dpp v24, v124, v120 row_newbcast:2 row_mask:0xf bank_mask:0xf
    v_and_b32_dpp v25, v124, v121 row_newbcast:2 row_mask:0xf bank_mask:0xf
    v_and_b32_dpp v26, v124, v122 row_newbcast:2 row_mask:0xf bank_mask:0xf
    v_and_b32_dpp v27, v124, v123 row_newbcast:2 row_mask:0xf bank_mask:0xf
    v_mfma_f32_16x16x32_bf16 v[12:15], v[28:31], v[140:143], v[12:15]
    s_waitcnt vmcnt(5)
    buffer_load_dwordx4 v[140:143], v4, s[32:35], s72 offen nt
    s_add_u32 s72, s72, 521216
    v_and_b32_dpp v28, v124, v120 row_newbcast:10 row_mask:0xf bank_mask:0xf
    v_and_b32_dpp v29, v124, v121 row_newbcast:10 row_mask:0xf bank_mask:0xf
    v_and_b32_dpp v30, v124, v122 row_newbcast:10 row_mask:0xf bank_mask:0xf
    v_and_b32_dpp v31, v124, v123 row_newbcast:10 row_mask:0xf bank_mask:0xf
    v_mfma_f32_16x16x32_bf16 v[12:15], v[24:27], v[144:147], v[12:15]
    s_waitcnt vmcnt(5)
    buffer_load_dwordx4 v[144:147], v4, s[32:35], s72 offen nt
    s_add_u32 s72, s72, 1024
    v_and_b32_dpp v24, v124, v120 row_newbcast:6 row_mask:0xf bank_mask:0xf
    v_and_b32_dpp v25, v124, v121 row_newbcast:6 row_mask:0xf bank_mask:0xf
    v_and_b32_dpp v26, v124, v122 row_newbcast:6 row_mask:0xf bank_mask:0xf
    v_and_b32_dpp v27, v124, v123 row_newbcast:6 row_mask:0xf bank_mask:0xf
    v_mfma_f32_16x16x32_bf16 v[12:15], v[28:31], v[148:151], v[12:15]
    s_waitcnt vmcnt(5)
    buffer_load_dwordx4 v[148:151], v4, s[32:35], s72 offen nt
    s_add_u32 s72, s72, 1024
    s_waitcnt lgkmcnt(0)
    v_sub_f32 v125, v125, v226
    v_mul_f32 v125, s76, v125
    v_exp_f32 v125, v125
    s_nop 0
    v_add_f32 v127, v127, v125
    v_cvt_pk_bf16_f32 v125, v125, v125
    v_and_b32_dpp v28, v124, v120 row_newbcast:14 row_mask:0xf bank_mask:0xf
    v_and_b32_dpp v29, v124, v121 row_newbcast:14 row_mask:0xf bank_mask:0xf
    v_and_b32_dpp v30, v124, v122 row_newbcast:14 row_mask:0xf bank_mask:0xf
    v_and_b32_dpp v31, v124, v123 row_newbcast:14 row_mask:0xf bank_mask:0xf
    v_mfma_f32_16x16x32_bf16 v[12:15], v[24:27], v[152:155], v[12:15]
    s_waitcnt vmcnt(5)
    buffer_load_dwordx4 v[152:155], v4, s[32:35], s72 offen nt
    s_add_u32 s72, s72, 1024
    s_memrealtime s[64:65]
    ds_read_b64 v[242:243], v247 offset:46416
    v_and_b32_dpp v24, v124, v120 row_newbcast:1 row_mask:0xf bank_mask:0xf
    v_and_b32_dpp v25, v124, v121 row_newbcast:1 row_mask:0xf bank_mask:0xf
    v_and_b32_dpp v26, v124, v122 row_newbcast:1 row_mask:0xf bank_mask:0xf
    v_and_b32_dpp v27, v124, v123 row_newbcast:1 row_mask:0xf bank_mask:0xf
    v_mfma_f32_16x16x32_bf16 v[12:15], v[28:31], v[156:159], v[12:15]
    s_waitcnt vmcnt(5)
    buffer_load_dwordx4 v[156:159], v4, s[32:35], s72 offen nt
    s_add_u32 s72, s72, 3666944
    v_and_b32_dpp v28, v124, v120 row_newbcast:9 row_mask:0xf bank_mask:0xf
    v_and_b32_dpp v29, v124, v121 row_newbcast:9 row_mask:0xf bank_mask:0xf
    v_and_b32_dpp v30, v124, v122 row_newbcast:9 row_mask:0xf bank_mask:0xf
    v_and_b32_dpp v31, v124, v123 row_newbcast:9 row_mask:0xf bank_mask:0xf
    v_mfma_f32_16x16x32_bf16 v[12:15], v[24:27], v[160:163], v[12:15]
    s_waitcnt vmcnt(5)
    buffer_load_dwordx4 v[160:163], v4, s[32:35], s72 offen nt
    s_add_u32 s72, s72, 1024
    v_and_b32_dpp v24, v124, v120 row_newbcast:5 row_mask:0xf bank_mask:0xf
    v_and_b32_dpp v25, v124, v121 row_newbcast:5 row_mask:0xf bank_mask:0xf
    v_and_b32_dpp v26, v124, v122 row_newbcast:5 row_mask:0xf bank_mask:0xf
    v_and_b32_dpp v27, v124, v123 row_newbcast:5 row_mask:0xf bank_mask:0xf
    v_mfma_f32_16x16x32_bf16 v[12:15], v[28:31], v[164:167], v[12:15]
    s_waitcnt vmcnt(5)
    buffer_load_dwordx4 v[164:167], v4, s[32:35], s72 offen nt
    s_add_u32 s72, s72, 1024
    v_and_b32_dpp v28, v124, v120 row_newbcast:13 row_mask:0xf bank_mask:0xf
    v_and_b32_dpp v29, v124, v121 row_newbcast:13 row_mask:0xf bank_mask:0xf
    v_and_b32_dpp v30, v124, v122 row_newbcast:13 row_mask:0xf bank_mask:0xf
    v_and_b32_dpp v31, v124, v123 row_newbcast:13 row_mask:0xf bank_mask:0xf
    v_mfma_f32_16x16x32_bf16 v[12:15], v[24:27], v[168:171], v[12:15]
    s_waitcnt vmcnt(5)
    buffer_load_dwordx4 v[168:171], v4, s[32:35], s72 offen nt
    s_add_u32 s72, s72, 1024
    v_and_b32_dpp v24, v124, v120 row_newbcast:3 row_mask:0xf bank_mask:0xf
    v_and_b32_dpp v25, v124, v121 row_newbcast:3 row_mask:0xf bank_mask:0xf
    v_and_b32_dpp v26, v124, v122 row_newbcast:3 row_mask:0xf bank_mask:0xf
    v_and_b32_dpp v27, v124, v123 row_newbcast:3 row_mask:0xf bank_mask:0xf
    v_mfma_f32_16x16x32_bf16 v[12:15], v[28:31], v[172:175], v[12:15]
    s_waitcnt vmcnt(5)
    buffer_load_dwordx4 v[172:175], v4, s[32:35], s72 offen nt
    s_add_u32 s72, s72, 521216
    s_waitcnt lgkmcnt(0)
    v_readfirstlane_b32 s62, v242
    v_readfirstlane_b32 s63, v243
    s_sub_u32 s68, s64, s69
    s_add_u32 s69, s69, 216
    s_add_u32 s67, s67, 1
    v_mov_b32 v244, s68
    v_mov_b32 v245, s67
    ds_write_b64 v246, v[244:245] offset:46432
    s_sub_u32 s68, s68, s62
    s_and_b32 s68, s68, s63
    s_mov_b32 s70, 0
    s_cmp_gt_i32 s68, -60
    s_addc_u32 s70, s70, 0
    s_cmp_gt_i32 s68, 25
    s_addc_u32 s70, s70, 0
    s_cmp_gt_i32 s68, 90
    s_addc_u32 s70, s70, 0
    v_and_b32_dpp v28, v124, v120 row_newbcast:11 row_mask:0xf bank_mask:0xf
    v_and_b32_dpp v29, v124, v121 row_newbcast:11 row_mask:0xf bank_mask:0xf
    v_and_b32_dpp v30, v124, v122 row_newbcast:11 row_mask:0xf bank_mask:0xf
    v_and_b32_dpp v31, v124, v123 row_newbcast:11 row_mask:0xf bank_mask:0xf
    v_mfma_f32_16x16x32_bf16 v[12:15], v[24:27], v[176:179], v[12:15]
    s_waitcnt vmcnt(5)
    buffer_load_dwordx4 v[176:179], v4, s[32:35], s72 offen nt
    s_add_u32 s72, s72, 1024
    v_and_b32_dpp v24, v124, v120 row_newbcast:7 row_mask:0xf bank_mask:0xf
    v_and_b32_dpp v25, v124, v121 row_newbcast:7 row_mask:0xf bank_mask:0xf
    v_and_b32_dpp v26, v124, v122 row_newbcast:7 row_mask:0xf bank_mask:0xf
    v_and_b32_dpp v27, v124, v123 row_newbcast:7 row_mask:0xf bank_mask:0xf
    v_mfma_f32_16x16x32_bf16 v[12:15], v[28:31], v[180:183], v[12:15]
    s_waitcnt vmcnt(5)
    buffer_load_dwordx4 v[180:183], v4, s[32:35], s72 offen nt
    s_add_u32 s72, s72, 1024
    v_and_b32_dpp v28, v124, v120 row_newbcast:15 row_mask:0xf bank_mask:0xf
    v_and_b32_dpp v29, v124, v121 row_newbcast:15 row_mask:0xf bank_mask:0xf
    v_and_b32_dpp v30, v124, v122 row_newbcast:15 row_mask:0xf bank_mask:0xf
    v_and_b32_dpp v31, v124, v123 row_newbcast:15 row_mask:0xf bank_mask:0xf
    v_mfma_f32_16x16x32_bf16 v[12:15], v[24:27], v[184:187], v[12:15]
    s_waitcnt vmcnt(5)
    buffer_load_dwordx4 v[184:187], v4, s[32:35], s72 offen nt
    s_add_u32 s72, s72, 1024
    v_and_b32_dpp v24, v125, v120 row_newbcast:0 row_mask:0xf bank_mask:0xf
    v_and_b32_dpp v25, v125, v121 row_newbcast:0 row_mask:0xf bank_mask:0xf
    v_and_b32_dpp v26, v125, v122 row_newbcast:0 row_mask:0xf bank_mask:0xf
    v_and_b32_dpp v27, v125, v123 row_newbcast:0 row_mask:0xf bank_mask:0xf
    v_mov_b32 v124, v125
    v_mfma_f32_16x16x32_bf16 v[12:15], v[28:31], v[188:191], v[12:15]
    s_waitcnt vmcnt(5)
    buffer_load_dwordx4 v[188:191], v4, s[32:35], s72 offen nt
    s_or_b32 s72, s72, 4291428351
    s_add_u32 s72, s72, 1
    s_and_b32 s72, s72, 3538944
    s_nop 2
    s_branch L_v4_end
L_v4_3:
    v_add_u32 v224, 256, v224
    ds_read_b32 v125, v224
    v_and_b32_dpp v28, v124, v120 row_newbcast:8 row_mask:0xf bank_mask:0xf
    v_and_b32_dpp v29, v124, v121 row_newbcast:8 row_mask:0xf bank_mask:0xf
    v_and_b32_dpp v30, v124, v122 row_newbcast:8 row_mask:0xf bank_mask:0xf
    v_and_b32_dpp v31, v124, v123 row_newbcast:8 row_mask:0xf bank_mask:0xf
    v_mfma_f32_16x16x32_bf16 v[12:15], v[24:27], v[128:131], v[12:15]
    s_waitcnt vmcnt(6)
    buffer_load_dwordx4 v[128:131], v4, s[32:35], s72 offen nt
    s_add_u32 s72, s72, 1024
    v_and_b32_dpp v24, v124, v120 row_newbcast:4 row_mask:0xf bank_mask:0xf
    v_and_b32_dpp v25, v124, v121 row_newbcast:4 row_mask:0xf bank_mask:0xf
    v_and_b32_dpp v26, v124, v122 row_newbcast:4 row_mask:0xf bank_mask:0xf
    v_and_b32_dpp v27, v124, v123 row_newbcast:4 row_mask:0xf bank_mask:0xf
    v_mfma_f32_16x16x32_bf16 v[12:15], v[28:31], v[132:135], v[12:15]
    s_waitcnt vmcnt(6)
    buffer_load_dwordx4 v[132:135], v4, s[32:35], s72 offen nt
    s_add_u32 s72, s72, 1024
    v_and_b32_dpp v28, v124, v120 row_newbcast:12 row_mask:0xf bank_mask:0xf
    v_and_b32_dpp v29, v124, v121 row_newbcast:12 row_mask:0xf bank_mask:0xf
    v_and_b32_dpp v30, v124, v122 row_newbcast:12 row_mask:0xf bank_mask:0xf
    v_and_b32_dpp v31, v124, v123 row_newbcast:12 row_mask:0xf bank_mask:0xf
    v_mfma_f32_16x16x32_bf16 v[12:15], v[24:27], v[136:139], v[12:15]
    s_waitcnt vmcnt(6)
    buffer_load_dwordx4 v[136:139], v4, s[32:35], s72 offen nt
    s_add_u32 s72, s72, 1024
    v_and_b32_dpp v24, v124, v120 row_newbcast:2 row_mask:0xf bank_mask:0xf
    v_and_b32_dpp v25, v124, v121 row_newbcast:2 row_mask:0xf bank_mask:0xf
    v_and_b32_dpp v26, v124, v122 row_newbcast:2 row_mask:0xf bank_mask:0xf
    v_and_b32_dpp v27, v124, v123 row_newbcast:2 row_mask:0xf bank_mask:0xf
    v_mfma_f32_16x16x32_bf16 v[12:15], v[28:31], v[140:143], v[12:15]
    s_waitcnt vmcnt(6)
    buffer_load_dwordx4 v[140:143], v4, s[32:35], s72 offen nt
    s_add_u32 s72, s72, 521216
    v_and_b32_dpp v28, v124, v120 row_newbcast:10 row_mask:0xf bank_mask:0xf
    v_and_b32_dpp v29, v124, v121 row_newbcast:10 row_mask:0xf bank_mask:0xf
    v_and_b32_dpp v30, v124, v122 row_newbcast:10 row_mask:0xf bank_mask:0xf
    v_and_b32_dpp v31, v124, v123 row_newbcast:10 row_mask:0xf bank_mask:0xf
    v_mfma_f32_16x16x32_bf16 v[12:15], v[24:27], v[144:147], v[12:15]
    s_waitcnt vmcnt(6)
    buffer_load_dwordx4 v[144:147], v4, s[32:35], s72 offen nt
    s_add_u32 s72, s72, 1024
    v_and_b32_dpp v24, v124, v120 row_newbcast:6 row_mask:0xf bank_mask:0xf
    v_and_b32_dpp v25, v124, v121 row_newbcast:6 row_mask:0xf bank_mask:0xf
    v_and_b32_dpp v26, v124, v122 row_newbcast:6 row_mask:0xf bank_mask:0xf
    v_and_b32_dpp v27, v124, v123 row_newbcast:6 row_mask:0xf bank_mask:0xf
    v_mfma_f32_16x16x32_bf16 v[12:15], v[28:31], v[148:151], v[12:15]
    s_waitcnt vmcnt(6)
    buffer_load_dwordx4 v[148:151], v4, s[32:35], s72 offen nt
    s_add_u32 s72, s72, 1024
    s_waitcnt lgkmcnt(0)
    v_sub_f32 v125, v125, v226
    v_mul_f32 v125, s76, v125
    v_exp_f32 v125, v125
    s_nop 0
    v_add_f32 v127, v127, v125
    v_cvt_pk_bf16_f32 v125, v125, v125
    v_and_b32_dpp v28, v124, v120 row_newbcast:14 row_mask:0xf bank_mask:0xf
    v_and_b32_dpp v29, v124, v121 row_newbcast:14 row_mask:0xf bank_mask:0xf
    v_and_b32_dpp v30, v124, v122 row_newbcast:14 row_mask:0xf bank_mask:0xf
    v_and_b32_dpp v31, v124, v123 row_newbcast:14 row_mask:0xf bank_mask:0xf
    v_mfma_f32_16x16x32_bf16 v[12:15], v[24:27], v[152:155], v[12:15]
    s_waitcnt vmcnt(6)
    buffer_load_dwordx4 v[152:155], v4, s[32:35], s72 offen nt
    s_add_u32 s72, s72, 1024
    s_memrealtime s[64:65]
    ds_read_b64 v[242:243], v247 offset:46416
    v_and_b32_dpp v24, v124, v120 row_newbcast:1 row_mask:0xf bank_mask:0xf
    v_and_b32_dpp v25, v124, v121 row_newbcast:1 row_mask:0xf bank_mask:0xf
    v_and_b32_dpp v26, v124, v122 row_newbcast:1 row_mask:0xf bank_mask:0xf
    v_and_b32_dpp v27, v124, v123 row_newbcast:1 row_mask:0xf bank_mask:0xf
    v_mfma_f32_16x16x32_bf16 v[12:15], v[28:31], v[156:159], v[12:15]
    s_waitcnt vmcnt(6)
    buffer_load_dwordx4 v[156:159], v4, s[32:35], s72 offen nt
    s_add_u32 s72, s72, 3666944
    v_and_b32_dpp v28, v124, v120 row_newbcast:9 row_mask:0xf bank_mask:0xf
    v_and_b32_dpp v29, v124, v121 row_newbcast:9 row_mask:0xf bank_mask:0xf
    v_and_b32_dpp v30, v124, v122 row_newbcast:9 row_mask:0xf bank_mask:0xf
    v_and_b32_dpp v31, v124, v123 row_newbcast:9 row_mask:0xf bank_mask:0xf
    v_mfma_f32_16x16x32_bf16 v[12:15], v[24:27], v[160:163], v[12:15]
    s_waitcnt vmcnt(6)
    buffer_load_dwordx4 v[160:163], v4, s[32:35], s72 offen nt
    s_add_u32 s72, s72, 1024
    v_and_b32_dpp v24, v124, v120 row_newbcast:5 row_mask:0xf bank_mask:0xf
    v_and_b32_dpp v25, v124, v121 row_newbcast:5 row_mask:0xf bank_mask:0xf
    v_and_b32_dpp v26, v124, v122 row_newbcast:5 row_mask:0xf bank_mask:0xf
    v_and_b32_dpp v27, v124, v123 row_newbcast:5 row_mask:0xf bank_mask:0xf
    v_mfma_f32_16x16x32_bf16 v[12:15], v[28:31], v[164:167], v[12:15]
    s_waitcnt vmcnt(6)
    buffer_load_dwordx4 v[164:167], v4, s[32:35], s72 offen nt
    s_add_u32 s72, s72, 1024
    v_and_b32_dpp v28, v124, v120 row_newbcast:13 row_mask:0xf bank_mask:0xf
    v_and_b32_dpp v29, v124, v121 row_newbcast:13 row_mask:0xf bank_mask:0xf
    v_and_b32_dpp v30, v124, v122 row_newbcast:13 row_mask:0xf bank_mask:0xf
    v_and_b32_dpp v31, v124, v123 row_newbcast:13 row_mask:0xf bank_mask:0xf
    v_mfma_f32_16x16x32_bf16 v[12:15], v[24:27], v[168:171], v[12:15]
    s_waitcnt vmcnt(6)
    buffer_load_dwordx4 v[168:171], v4, s[32:35], s72 offen nt
    s_add_u32 s72, s72, 1024
    v_and_b32_dpp v24, v124, v120 row_newbcast:3 row_mask:0xf bank_mask:0xf
    v_and_b32_dpp v25, v124, v121 row_newbcast:3 row_mask:0xf bank_mask:0xf
    v_and_b32_dpp v26, v124, v122 row_newbcast:3 row_mask:0xf bank_mask:0xf
    v_and_b32_dpp v27, v124, v123 row_newbcast:3 row_mask:0xf bank_mask:0xf
    v_mfma_f32_16x16x32_bf16 v[12:15], v[28:31], v[172:175], v[12:15]
    s_waitcnt vmcnt(6)
    buffer_load_dwordx4 v[172:175], v4, s[32:35], s72 offen nt
    s_add_u32 s72, s72, 521216
    s_waitcnt lgkmcnt(0)
    v_readfirstlane_b32 s62, v242
    v_readfirstlane_b32 s63, v243
    s_sub_u32 s68, s64, s69
    s_add_u32 s69, s69, 216
    s_add_u32 s67, s67, 1
    v_mov_b32 v244, s68
    v_mov_b32 v245, s67
    ds_write_b64 v246, v[244:245] offset:46432
    s_sub_u32 s68, s68, s62
    s_and_b32 s68, s68, s63
    s_mov_b32 s70, 0
    s_cmp_gt_i32 s68, -60
    s_addc_u32 s70, s70, 0
    s_cmp_gt_i32 s68, 25
    s_addc_u32 s70, s70, 0
    s_cmp_gt_i32 s68, 90
    s_addc_u32 s70, s70, 0
    v_and_b32_dpp v28, v124, v120 row_newbcast:11 row_mask:0xf bank_mask:0xf
    v_and_b32_dpp v29, v124, v121 row_newbcast:11 row_mask:0xf bank_mask:0xf
    v_and_b32_dpp v30, v124, v122 row_newbcast:11 row_mask:0xf bank_mask:0xf
    v_and_b32_dpp v31, v124, v123 row_newbcast:11 row_mask:0xf bank_mask:0xf
    v_mfma_f32_16x16x32_bf16 v[12:15], v[24:27], v[176:179], v[12:15]
    s_waitcnt vmcnt(6)
    buffer_load_dwordx4 v[176:179], v4, s[32:35], s72 offen nt
    s_add_u32 s72, s72, 1024
    v_and_b32_dpp v24, v124, v120 row_newbcast:7 row_mask:0xf bank_mask:0xf
    v_and_b32_dpp v25, v124, v121 row_newbcast:7 row_mask:0xf bank_mask:0xf
    v_and_b32_dpp v26, v124, v122 row_newbcast:7 row_mask:0xf bank_mask:0xf
    v_and_b32_dpp v27, v124, v123 row_newbcast:7 row_mask:0xf bank_mask:0xf
    v_mfma_f32_16x16x32_bf16 v[12:15], v[28:31], v[180:183], v[12:15]
    s_waitcnt vmcnt(6)
    buffer_load_dwordx4 v[180:183], v4, s[32:35], s72 offen nt
    s_add_u32 s72, s72, 1024
    v_and_b32_dpp v28, v124, v120 row_newbcast:15 row_mask:0xf bank_mask:0xf
    v_and_b32_dpp v29, v124, v121 row_newbcast:15 row_mask:0xf bank_mask:0xf
    v_and_b32_dpp v30, v124, v122 row_newbcast:15 row_mask:0xf bank_mask:0xf
    v_and_b32_dpp v31, v124, v123 row_newbcast:15 row_mask:0xf bank_mask:0xf
    v_mfma_f32_16x16x32_bf16 v[12:15], v[24:27], v[184:187], v[12:15]
    s_waitcnt vmcnt(6)
    buffer_load_dwordx4 v[184:187], v4, s[32:35], s72 offen nt
    s_add_u32 s72, s72, 1024
    v_and_b32_dpp v24, v125, v120 row_newbcast:0 row_mask:0xf bank_mask:0xf
    v_and_b32_dpp v25, v125, v121 row_newbcast:0 row_mask:0xf bank_mask:0xf
    v_and_b32_dpp v26, v125, v122 row_newbcast:0 row_mask:0xf bank_mask:0xf
    v_and_b32_dpp v27, v125, v123 row_newbcast:0 row_mask:0xf bank_mask:0xf
    v_mov_b32 v124, v125
    v_mfma_f32_16x16x32_bf16 v[12:15], v[28:31], v[188:191], v[12:15]
    s_waitcnt vmcnt(6)
    buffer_load_dwordx4 v[188:191], v4, s[32:35], s72 offen nt
    s_or_b32 s72, s72, 4291428351
    s_add_u32 s72, s72, 1
    s_and_b32 s72, s72, 3538944
    s_nop 2
L_v4_end:
    s_sub_u32 s73, s73, 1
    s_cmp_lg_u32 s73, 0
    s_cbranch_scc1 L_vloop
L_tail0:
    v_add_u32 v224, 256, v224
    ds_read_b32 v125, v224
    v_and_b32_dpp v28, v124, v120 row_newbcast:8 row_mask:0xf bank_mask:0xf
    v_and_b32_dpp v29, v124, v121 row_newbcast:8 row_mask:0xf bank_mask:0xf
    v_and_b32_dpp v30, v124, v122 row_newbcast:8 row_mask:0xf bank_mask:0xf
    v_and_b32_dpp v31, v124, v123 row_newbcast:8 row_mask:0xf bank_mask:0xf
    v_mfma_f32_16x16x32_bf16 v[12:15], v[24:27], v[32:35], v[12:15]
    v_and_b32_dpp v24, v124, v120 row_newbcast:4 row_mask:0xf bank_mask:0xf
    v_and_b32_dpp v25, v124, v121 row_newbcast:4 row_mask:0xf bank_mask:0xf
    v_and_b32_dpp v26, v124, v122 row_newbcast:4 row_mask:0xf bank_mask:0xf
    v_and_b32_dpp v27, v124, v123 row_newbcast:4 row_mask:0xf bank_mask:0xf
    v_mfma_f32_16x16x32_bf16 v[12:15], v[28:31], v[36:39], v[12:15]
    v_and_b32_dpp v28, v124, v120 row_newbcast:12 row_mask:0xf bank_mask:0xf
    v_and_b32_dpp v29, v124, v121 row_newbcast:12 row_mask:0xf bank_mask:0xf
    v_and_b32_dpp v30, v124, v122 row_newbcast:12 row_mask:0xf bank_mask:0xf
    v_and_b32_dpp v31, v124, v123 row_newbcast:12 row_mask:0xf bank_mask:0xf
    v_mfma_f32_16x16x32_bf16 v[12:15], v[24:27], v[40:43], v[12:15]
    v_and_b32_dpp v24, v124, v120 row_newbcast:2 row_mask:0xf bank_mask:0xf
    v_and_b32_dpp v25, v124, v121 row_newbcast:2 row_mask:0xf bank_mask:0xf
    v_and_b32_dpp v26, v124, v122 row_newbcast:2 row_mask:0xf bank_mask:0xf
    v_and_b32_dpp v27, v124, v123 row_newbcast:2 row_mask:0xf bank_mask:0xf
    v_mfma_f32_16x16x32_bf16 v[12:15], v[28:31], v[44:47], v[12:15]
    v_and_b32_dpp v28, v124, v120 row_newbcast:10 row_mask:0xf bank_mask:0xf
    v_and_b32_dpp v29, v124, v121 row_newbcast:10 row_mask:0xf bank_mask:0xf
    v_and_b32_dpp v30, v124, v122 row_newbcast:10 row_mask:0xf bank_mask:0xf
    v_and_b32_dpp v31, v124, v123 row_newbcast:10 row_mask:0xf bank_mask:0xf
    v_mfma_f32_16x16x32_bf16 v[12:15], v[24:27], v[48:51], v[12:15]
    buffer_load_dwordx4 v[192:195], v240, s[40:43], s75 offen nt
    s_add_u32 s75, s75, 2048
    v_and_b32_dpp v24, v124, v120 row_newbcast:6 row_mask:0xf bank_mask:0xf
    v_and_b32_dpp v25, v124, v121 row_newbcast:6 row_mask:0xf bank_mask:0xf
    v_and_b32_dpp v26, v124, v122 row_newbcast:6 row_mask:0xf bank_mask:0xf
    v_and_b32_dpp v27, v124, v123 row_newbcast:6 row_mask:0xf bank_mask:0xf
    v_mfma_f32_16x16x32_bf16 v[12:15], v[28:31], v[52:55], v[12:15]
    s_waitcnt lgkmcnt(0)
    v_sub_f32 v125, v125, v226
    v_mul_f32 v125, s76, v125
    v_exp_f32 v125, v125
    s_nop 0
    v_add_f32 v127, v127, v125
    v_cvt_pk_bf16_f32 v125, v125, v125
    v_and_b32_dpp v28, v124, v120 row_newbcast:14 row_mask:0xf bank_mask:0xf
    v_and_b32_dpp v29, v124, v121 row_newbcast:14 row_mask:0xf bank_mask:0xf
    v_and_b32_dpp v30, v124, v122 row_newbcast:14 row_mask:0xf bank_mask:0xf
    v_and_b32_dpp v31, v124, v123 row_newbcast:14 row_mask:0xf bank_mask:0xf
    v_mfma_f32_16x16x32_bf16 v[12:15], v[24:27], v[56:59], v[12:15]
    v_and_b32_dpp v24, v124, v120 row_newbcast:1 row_mask:0xf bank_mask:0xf
    v_and_b32_dpp v25, v124, v121 row_newbcast:1 row_mask:0xf bank_mask:0xf
    v_and_b32_dpp v26, v124, v122 row_newbcast:1 row_mask:0xf bank_mask:0xf
    v_and_b32_dpp v27, v124, v123 row_newbcast:1 row_mask:0xf bank_mask:0xf
    v_mfma_f32_16x16x32_bf16 v[12:15], v[28:31], v[60:63], v[12:15]
    v_and_b32_dpp v28, v124, v120 row_newbcast:9 row_mask:0xf bank_mask:0xf
    v_and_b32_dpp v29, v124, v121 row_newbcast:9 row_mask:0xf bank_mask:0xf
    v_and_b32_dpp v30, v124, v122 row_newbcast:9 row_mask:0xf bank_mask:0xf
    v_and_b32_dpp v31, v124, v123 row_newbcast:9 row_mask:0xf bank_mask:0xf
    v_mfma_f32_16x16x32_bf16 v[12:15], v[24:27], v[64:67], v[12:15]
    v_and_b32_dpp v24, v124, v120 row_newbcast:5 row_mask:0xf bank_mask:0xf
    v_and_b32_dpp v25, v124, v121 row_newbcast:5 row_mask:0xf bank_mask:0xf
    v_and_b32_dpp v26, v124, v122 row_newbcast:5 row_mask:0xf bank_mask:0xf
    v_and_b32_dpp v27, v124, v123 row_newbcast:5 row_mask:0xf bank_mask:0xf
    v_mfma_f32_16x16x32_bf16 v[12:15], v[28:31], v[68:71], v[12:15]
    buffer_load_dwordx4 v[196:199], v240, s[40:43], s75 offen nt
    s_add_u32 s75, s75, 2048
    v_and_b32_dpp v28, v124, v120 row_newbcast:13 row_mask:0xf bank_mask:0xf
    v_and_b32_dpp v29, v124, v121 row_newbcast:13 row_mask:0xf bank_mask:0xf
    v_and_b32_dpp v30, v124, v122 row_newbcast:13 row_mask:0xf bank_mask:0xf
    v_and_b32_dpp v31, v124, v123 row_newbcast:13 row_mask:0xf bank_mask:0xf
    v_mfma_f32_16x16x32_bf16 v[12:15], v[24:27], v[72:75], v[12:15]
    v_and_b32_dpp v24, v124, v120 row_newbcast:3 row_mask:0xf bank_mask:0xf
    v_and_b32_dpp v25, v124, v121 row_newbcast:3 row_mask:0xf bank_mask:0xf
    v_and_b32_dpp v26, v124, v122 row_newbcast:3 row_mask:0xf bank_mask:0xf
    v_and_b32_dpp v27, v124, v123 row_newbcast:3 row_mask:0xf bank_mask:0xf
    v_mfma_f32_16x16x32_bf16 v[12:15], v[28:31], v[76:79], v[12:15]
    v_and_b32_dpp v28, v124, v120 row_newbcast:11 row_mask:0xf bank_mask:0xf
    v_and_b32_dpp v29, v124, v121 row_newbcast:11 row_mask:0xf bank_mask:0xf
    v_and_b32_dpp v30, v124, v122 row_newbcast:11 row_mask:0xf bank_mask:0xf
    v_and_b32_dpp v31, v124, v123 row_newbcast:11 row_mask:0xf bank_mask:0xf
    v_mfma_f32_16x16x32_bf16 v[12:15], v[24:27], v[80:83], v[12:15]
    v_and_b32_dpp v24, v124, v120 row_newbcast:7 row_mask:0xf bank_mask:0xf
    v_and_b32_dpp v25, v124, v121 row_newbcast:7 row_mask:0xf bank_mask:0xf
    v_and_b32_dpp v26, v124, v122 row_newbcast:7 row_mask:0xf bank_mask:0xf
    v_and_b32_dpp v27, v124, v123 row_newbcast:7 row_mask:0xf bank_mask:0xf
    v_mfma_f32_16x16x32_bf16 v[12:15], v[28:31], v[84:87], v[12:15]
    v_and_b32_dpp v28, v124, v120 row_newbcast:15 row_mask:0xf bank_mask:0xf
    v_and_b32_dpp v29, v124, v121 row_newbcast:15 row_mask:0xf bank_mask:0xf
    v_and_b32_dpp v30, v124, v122 row_newbcast:15 row_mask:0xf bank_mask:0xf
    v_and_b32_dpp v31, v124, v123 row_newbcast:15 row_mask:0xf bank_mask:0xf
    v_mfma_f32_16x16x32_bf16 v[12:15], v[24:27], v[88:91], v[12:15]
    buffer_load_dwordx4 v[200:203], v240, s[40:43], s75 offen nt
    s_add_u32 s75, s75, 2048
    v_and_b32_dpp v24, v125, v120 row_newbcast:0 row_mask:0xf bank_mask:0xf
    v_and_b32_dpp v25, v125, v121 row_newbcast:0 row_mask:0xf bank_mask:0xf
    v_and_b32_dpp v26, v125, v122 row_newbcast:0 row_mask:0xf bank_mask:0xf
    v_and_b32_dpp v27, v125, v123 row_newbcast:0 row_mask:0xf bank_mask:0xf
    v_mov_b32 v124, v125
    v_mfma_f32_16x16x32_bf16 v[12:15], v[28:31], v[92:95], v[12:15]
    s_nop 0
    v_and_b32_dpp v28, v124, v120 row_newbcast:8 row_mask:0xf bank_mask:0xf
    v_and_b32_dpp v29, v124, v121 row_newbcast:8 row_mask:0xf bank_mask:0xf
    v_and_b32_dpp v30, v124, v122 row_newbcast:8 row_mask:0xf bank_mask:0xf
    v_and_b32_dpp v31, v124, v123 row_newbcast:8 row_mask:0xf bank_mask:0xf
    v_mfma_f32_16x16x32_bf16 v[12:15], v[24:27], v[128:131], v[12:15]
    v_and_b32_dpp v24, v124, v120 row_newbcast:4 row_mask:0xf bank_mask:0xf
    v_and_b32_dpp v25, v124, v121 row_newbcast:4 row_mask:0xf bank_mask:0xf
    v_and_b32_dpp v26, v124, v122 row_newbcast:4 row_mask:0xf bank_mask:0xf
    v_and_b32_dpp v27, v124, v123 row_newbcast:4 row_mask:0xf bank_mask:0xf
    v_mfma_f32_16x16x32_bf16 v[12:15], v[28:31], v[132:135], v[12:15]
    v_and_b32_dpp v28, v124, v120 row_newbcast:12 row_mask:0xf bank_mask:0xf
    v_and_b32_dpp v29, v124, v121 row_newbcast:12 row_mask:0xf bank_mask:0xf
    v_and_b32_dpp v30, v124, v122 row_newbcast:12 row_mask:0xf bank_mask:0xf
    v_and_b32_dpp v31, v124, v123 row_newbcast:12 row_mask:0xf bank_mask:0xf
    v_mfma_f32_16x16x32_bf16 v[12:15], v[24:27], v[136:139], v[12:15]
    v_add_f32_dpp v127, v127, v127 row_ror:8 row_mask:0xf bank_mask:0xf
    s_nop 1
    v_add_f32_dpp v127, v127, v127 row_ror:4 row_mask:0xf bank_mask:0xf
    s_nop 1
    v_add_f32_dpp v127, v127, v127 row_ror:2 row_mask:0xf bank_mask:0xf
    s_nop 1
    v_add_f32_dpp v127, v127, v127 row_ror:1 row_mask:0xf bank_mask:0xf
    v_mov_b32 v16, v127
    s_nop 1
    v_permlane16_swap_b32 v127, v16
    v_add_f32 v127, v127, v16
    v_mov_b32 v16, v127
    s_nop 1
    v_permlane32_swap_b32 v127, v16
    v_add_f32 v127, v127, v16
    s_lshl_b32 s31, s3, 9
    v_mov_b32 v20, s31
    v_mov_b32 v16, v127
    v_mov_b32 v17, 0
    v_mov_b32 v18, 0
    v_mov_b32 v19, 0
    ds_write_b128 v20, v[16:19] offset:43008
    v_and_b32_dpp v24, v124, v120 row_newbcast:2 row_mask:0xf bank_mask:0xf
    v_and_b32_dpp v25, v124, v121 row_newbcast:2 row_mask:0xf bank_mask:0xf
    v_and_b32_dpp v26, v124, v122 row_newbcast:2 row_mask:0xf bank_mask:0xf
    v_and_b32_dpp v27, v124, v123 row_newbcast:2 row_mask:0xf bank_mask:0xf
    v_mfma_f32_16x16x32_bf16 v[12:15], v[28:31], v[140:143], v[12:15]
    buffer_load_dwordx4 v[204:207], v240, s[40:43], s75 offen nt
    s_add_u32 s75, s75, 2048
    v_and_b32_dpp v28, v124, v120 row_newbcast:10 row_mask:0xf bank_mask:0xf
    v_and_b32_dpp v29, v124, v121 row_newbcast:10 row_mask:0xf bank_mask:0xf
    v_and_b32_dpp v30, v124, v122 row_newbcast:10 row_mask:0xf bank_mask:0xf
    v_and_b32_dpp v31, v124, v123 row_newbcast:10 row_mask:0xf bank_mask:0xf
    v_mfma_f32_16x16x32_bf16 v[12:15], v[24:27], v[144:147], v[12:15]
    v_and_b32_dpp v24, v124, v120 row_newbcast:6 row_mask:0xf bank_mask:0xf
    v_and_b32_dpp v25, v124, v121 row_newbcast:6 row_mask:0xf bank_mask:0xf
    v_and_b32_dpp v26, v124, v122 row_newbcast:6 row_mask:0xf bank_mask:0xf
    v_and_b32_dpp v27, v124, v123 row_newbcast:6 row_mask:0xf bank_mask:0xf
    v_mfma_f32_16x16x32_bf16 v[12:15], v[28:31], v[148:151], v[12:15]
    v_and_b32_dpp v28, v124, v120 row_newbcast:14 row_mask:0xf bank_mask:0xf
    v_and_b32_dpp v29, v124, v121 row_newbcast:14 row_mask:0xf bank_mask:0xf
    v_and_b32_dpp v30, v124, v122 row_newbcast:14 row_mask:0xf bank_mask:0xf
    v_and_b32_dpp v31, v124, v123 row_newbcast:14 row_mask:0xf bank_mask:0xf
    v_mfma_f32_16x16x32_bf16 v[12:15], v[24:27], v[152:155], v[12:15]
    v_and_b32_dpp v24, v124, v120 row_newbcast:1 row_mask:0xf bank_mask:0xf
    v_and_b32_dpp v25, v124, v121 row_newbcast:1 row_mask:0xf bank_mask:0xf
    v_and_b32_dpp v26, v124, v122 row_newbcast:1 row_mask:0xf bank_mask:0xf
    v_and_b32_dpp v27, v124, v123 row_newbcast:1 row_mask:0xf bank_mask:0xf
    v_mfma_f32_16x16x32_bf16 v[12:15], v[28:31], v[156:159], v[12:15]
    v_and_b32_dpp v28, v124, v120 row_newbcast:9 row_mask:0xf bank_mask:0xf
    v_and_b32_dpp v29, v124, v121 row_newbcast:9 row_mask:0xf bank_mask:0xf
    v_and_b32_dpp v30, v124, v122 row_newbcast:9 row_mask:0xf bank_mask:0xf
    v_and_b32_dpp v31, v124, v123 row_newbcast:9 row_mask:0xf bank_mask:0xf
    v_mfma_f32_16x16x32_bf16 v[12:15], v[24:27], v[160:163], v[12:15]
    buffer_load_dwordx4 v[208:211], v240, s[40:43], s75 offen nt
    s_add_u32 s75, s75, 2048
    v_and_b32_dpp v24, v124, v120 row_newbcast:5 row_mask:0xf bank_mask:0xf
    v_and_b32_dpp v25, v124, v121 row_newbcast:5 row_mask:0xf bank_mask:0xf
    v_and_b32_dpp v26, v124, v122 row_newbcast:5 row_mask:0xf bank_mask:0xf
    v_and_b32_dpp v27, v124, v123 row_newbcast:5 row_mask:0xf bank_mask:0xf
    s_waitcnt vmcnt(11)
    v_mfma_f32_16x16x32_bf16 v[12:15], v[28:31], v[164:167], v[12:15]
    v_and_b32_dpp v28, v124, v120 row_newbcast:13 row_mask:0xf bank_mask:0xf
    v_and_b32_dpp v29, v124, v121 row_newbcast:13 row_mask:0xf bank_mask:0xf
    v_and_b32_dpp v30, v124, v122 row_newbcast:13 row_mask:0xf bank_mask:0xf
    v_and_b32_dpp v31, v124, v123 row_newbcast:13 row_mask:0xf bank_mask:0xf
    s_waitcnt vmcnt(10)
    v_mfma_f32_16x16x32_bf16 v[12:15], v[24:27], v[168:171], v[12:15]
    v_and_b32_dpp v24, v124, v120 row_newbcast:3 row_mask:0xf bank_mask:0xf
    v_and_b32_dpp v25, v124, v121 row_newbcast:3 row_mask:0xf bank_mask:0xf
    v_and_b32_dpp v26, v124, v122 row_newbcast:3 row_mask:0xf bank_mask:0xf
    v_and_b32_dpp v27, v124, v123 row_newbcast:3 row_mask:0xf bank_mask:0xf
    s_waitcnt vmcnt(9)
    v_mfma_f32_16x16x32_bf16 v[12:15], v[28:31], v[172:175], v[12:15]
    buffer_load_dwordx4 v[212:215], v240, s[40:43], s75 offen nt
    s_add_u32 s75, s75, 2048
    v_and_b32_dpp v28, v124, v120 row_newbcast:11 row_mask:0xf bank_mask:0xf
    v_and_b32_dpp v29, v124, v121 row_newbcast:11 row_mask:0xf bank_mask:0xf
    v_and_b32_dpp v30, v124, v122 row_newbcast:11 row_mask:0xf bank_mask:0xf
    v_and_b32_dpp v31, v124, v123 row_newbcast:11 row_mask:0xf bank_mask:0xf
    s_waitcnt vmcnt(9)
    v_mfma_f32_16x16x32_bf16 v[12:15], v[24:27], v[176:179], v[12:15]
    buffer_load_dwordx4 v[216:219], v240, s[40:43], s75 offen nt
    s_add_u32 s75, s75, 2048
    v_and_b32_dpp v24, v124, v120 row_newbcast:7 row_mask:0xf bank_mask:0xf
    v_and_b32_dpp v25, v124, v121 row_newbcast:7 row_mask:0xf bank_mask:0xf
    v_and_b32_dpp v26, v124, v122 row_newbcast:7 row_mask:0xf bank_mask:0xf
    v_and_b32_dpp v27, v124, v123 row_newbcast:7 row_mask:0xf bank_mask:0xf
    s_waitcnt vmcnt(9)
    v_mfma_f32_16x16x32_bf16 v[12:15], v[28:31], v[180:183], v[12:15]
    buffer_load_dwordx4 v[220:223], v240, s[40:43], s75 offen nt
    s_add_u32 s75, s75, 2048
    v_and_b32_dpp v28, v124, v120 row_newbcast:15 row_mask:0xf bank_mask:0xf
    v_and_b32_dpp v29, v124, v121 row_newbcast:15 row_mask:0xf bank_mask:0xf
    v_and_b32_dpp v30, v124, v122 row_newbcast:15 row_mask:0xf bank_mask:0xf
    v_and_b32_dpp v31, v124, v123 row_newbcast:15 row_mask:0xf bank_mask:0xf
    s_waitcnt vmcnt(9)
    v_mfma_f32_16x16x32_bf16 v[12:15], v[24:27], v[184:187], v[12:15]
    s_waitcnt vmcnt(8)
    v_mfma_f32_16x16x32_bf16 v[12:15], v[28:31], v[188:191], v[12:15]
    s_mov_b64 exec, s[78:79]
    s_nop 6
    ds_write_b128 v225, v[12:15] offset:40960
    s_mov_b64 exec, -1
    s_waitcnt lgkmcnt(0)
    s_barrier
    s_mov_b32 s77, 1048576
    s_and_b32 s74, s30, 0xff
L_p1:
    buffer_load_dwordx4 v[228:231], v233, s[56:59], 0 offen sc1 nt
    buffer_load_dwordx4 v[236:239], v232, s[56:59], 0 offen offset:512 sc1 nt
    s_waitcnt vmcnt(0)
    v_xor_b32 v228, s74, v228
    v_xor_b32 v229, s74, v229
    v_xor_b32 v230, s74, v230
    v_xor_b32 v231, s74, v231
    v_xor_b32 v236, s74, v236
    v_xor_b32 v237, s74, v237
    v_or_b32 v250, v228, v229
    v_or3_b32 v250, v250, v230, v231
    v_or3_b32 v250, v250, v236, v237
    v_and_b32 v250, 0xff, v250
    v_bitop3_b32 v250, v238, s30, v250 bitop3:0xbe
    v_bitop3_b32 v250, v239, s30, v250 bitop3:0xbe
    v_cmp_ne_u32 vcc, 0, v250
    s_nop 3
    s_cmp_eq_u64 vcc, 0
    s_cbranch_scc1 L_p1_ok
    s_sub_u32 s77, s77, 1
    s_cmp_eq_u32 s77, 0
    s_cbranch_scc1 L_p1_ok
    s_sleep 1
    s_branch L_p1
L_p1_ok:
    s_mov_b64 exec, -1
    v_mov_b32 v240, v237
    s_nop 1
    v_max_f32_dpp v240, v240, v240 quad_perm:[1,0,3,2] row_mask:0xf bank_mask:0xf
    s_nop 1
    v_max_f32_dpp v240, v240, v240 quad_perm:[2,3,0,1] row_mask:0xf bank_mask:0xf
    s_nop 1
    v_max_f32_dpp v240, v240, v240 row_half_mirror row_mask:0xf bank_mask:0xf
    v_sub_f32 v237, v237, v240
    v_mul_f32 v237, s76, v237
    v_exp_f32 v237, v237
    s_nop 0
    v_mul_f32 v236, v236, v237
    v_mul_f32 v228, v228, v237
    v_mul_f32 v229, v229, v237
    v_mul_f32 v230, v230, v237
    v_mul_f32 v231, v231, v237
    v_add_f32_dpp v236, v236, v236 quad_perm:[1,0,3,2] row_mask:0xf bank_mask:0xf
    v_add_f32_dpp v228, v228, v228 quad_perm:[1,0,3,2] row_mask:0xf bank_mask:0xf
    v_add_f32_dpp v229, v229, v229 quad_perm:[1,0,3,2] row_mask:0xf bank_mask:0xf
    v_add_f32_dpp v230, v230, v230 quad_perm:[1,0,3,2] row_mask:0xf bank_mask:0xf
    v_add_f32_dpp v231, v231, v231 quad_perm:[1,0,3,2] row_mask:0xf bank_mask:0xf
    v_add_f32_dpp v236, v236, v236 quad_perm:[2,3,0,1] row_mask:0xf bank_mask:0xf
    v_add_f32_dpp v228, v228, v228 quad_perm:[2,3,0,1] row_mask:0xf bank_mask:0xf
    v_add_f32_dpp v229, v229, v229 quad_perm:[2,3,0,1] row_mask:0xf bank_mask:0xf
    v_add_f32_dpp v230, v230, v230 quad_perm:[2,3,0,1] row_mask:0xf bank_mask:0xf
    v_add_f32_dpp v231, v231, v231 quad_perm:[2,3,0,1] row_mask:0xf bank_mask:0xf
    v_add_f32_dpp v236, v236, v236 row_half_mirror row_mask:0xf bank_mask:0xf
    v_add_f32_dpp v228, v228, v228 row_half_mirror row_mask:0xf bank_mask:0xf
    v_add_f32_dpp v229, v229, v229 row_half_mirror row_mask:0xf bank_mask:0xf
    v_add_f32_dpp v230, v230, v230 row_half_mirror row_mask:0xf bank_mask:0xf
    v_add_f32_dpp v231, v231, v231 row_half_mirror row_mask:0xf bank_mask:0xf
    v_rcp_f32 v236, v236
    s_nop 0
    v_mul_f32 v228, v228, v236
    v_mul_f32 v229, v229, v236
    v_mul_f32 v230, v230, v236
    v_mul_f32 v231, v231, v236
    v_cvt_pk_bf16_f32 v228, v228, v228
    v_cvt_pk_bf16_f32 v229, v229, v229
    v_cvt_pk_bf16_f32 v230, v230, v230
    v_cvt_pk_bf16_f32 v231, v231, v231
    v_and_b32_dpp v24, v228, v120 row_newbcast:0 row_mask:0xf bank_mask:0xf
    v_and_b32_dpp v25, v228, v121 row_newbcast:0 row_mask:0xf bank_mask:0xf
    v_and_b32_dpp v26, v228, v122 row_newbcast:0 row_mask:0xf bank_mask:0xf
    v_and_b32_dpp v27, v228, v123 row_newbcast:0 row_mask:0xf bank_mask:0xf
    v_and_b32_dpp v28, v229, v120 row_newbcast:0 row_mask:0xf bank_mask:0xf
    v_and_b32_dpp v29, v229, v121 row_newbcast:0 row_mask:0xf bank_mask:0xf
    v_and_b32_dpp v30, v229, v122 row_newbcast:0 row_mask:0xf bank_mask:0xf
    v_and_b32_dpp v31, v229, v123 row_newbcast:0 row_mask:0xf bank_mask:0xf
    v_mfma_f32_16x16x32_bf16 v[16:19], v[24:27], v[192:195], 0
    v_and_b32_dpp v24, v230, v120 row_newbcast:0 row_mask:0xf bank_mask:0xf
    v_and_b32_dpp v25, v230, v121 row_newbcast:0 row_mask:0xf bank_mask:0xf
    v_and_b32_dpp v26, v230, v122 row_newbcast:0 row_mask:0xf bank_mask:0xf
    v_and_b32_dpp v27, v230, v123 row_newbcast:0 row_mask:0xf bank_mask:0xf
    v_mfma_f32_16x16x32_bf16 v[16:19], v[28:31], v[196:199], v[16:19]
    v_and_b32_dpp v28, v231, v120 row_newbcast:0 row_mask:0xf bank_mask:0xf
    v_and_b32_dpp v29, v231, v121 row_newbcast:0 row_mask:0xf bank_mask:0xf
    v_and_b32_dpp v30, v231, v122 row_newbcast:0 row_mask:0xf bank_mask:0xf
    v_and_b32_dpp v31, v231, v123 row_newbcast:0 row_mask:0xf bank_mask:0xf
    v_mfma_f32_16x16x32_bf16 v[16:19], v[24:27], v[200:203], v[16:19]
    v_and_b32_dpp v24, v228, v120 row_newbcast:8 row_mask:0xf bank_mask:0xf
    v_and_b32_dpp v25, v228, v121 row_newbcast:8 row_mask:0xf bank_mask:0xf
    v_and_b32_dpp v26, v228, v122 row_newbcast:8 row_mask:0xf bank_mask:0xf
    v_and_b32_dpp v27, v228, v123 row_newbcast:8 row_mask:0xf bank_mask:0xf
    v_mfma_f32_16x16x32_bf16 v[16:19], v[28:31], v[204:207], v[16:19]
    v_and_b32_dpp v28, v229, v120 row_newbcast:8 row_mask:0xf bank_mask:0xf
    v_and_b32_dpp v29, v229, v121 row_newbcast:8 row_mask:0xf bank_mask:0xf
    v_and_b32_dpp v30, v229, v122 row_newbcast:8 row_mask:0xf bank_mask:0xf
    v_and_b32_dpp v31, v229, v123 row_newbcast:8 row_mask:0xf bank_mask:0xf
    v_mfma_f32_16x16x32_bf16 v[16:19], v[24:27], v[208:211], v[16:19]
    v_and_b32_dpp v24, v230, v120 row_newbcast:8 row_mask:0xf bank_mask:0xf
    v_and_b32_dpp v25, v230, v121 row_newbcast:8 row_mask:0xf bank_mask:0xf
    v_and_b32_dpp v26, v230, v122 row_newbcast:8 row_mask:0xf bank_mask:0xf
    v_and_b32_dpp v27, v230, v123 row_newbcast:8 row_mask:0xf bank_mask:0xf
    v_mfma_f32_16x16x32_bf16 v[16:19], v[28:31], v[212:215], v[16:19]
    v_and_b32_dpp v28, v231, v120 row_newbcast:8 row_mask:0xf bank_mask:0xf
    v_and_b32_dpp v29, v231, v121 row_newbcast:8 row_mask:0xf bank_mask:0xf
    v_and_b32_dpp v30, v231, v122 row_newbcast:8 row_mask:0xf bank_mask:0xf
    v_and_b32_dpp v31, v231, v123 row_newbcast:8 row_mask:0xf bank_mask:0xf
    v_mfma_f32_16x16x32_bf16 v[16:19], v[24:27], v[216:219], v[16:19]
    s_nop 0
    v_mfma_f32_16x16x32_bf16 v[16:19], v[28:31], v[220:223], v[16:19]
    s_mov_b64 exec, s[78:79]
    s_nop 6
    ds_write_b128 v225, v[16:19] offset:38912
    s_mov_b64 exec, -1
    s_waitcnt lgkmcnt(0)
    s_barrier
    s_endpgm
L_comm0:
    s_waitcnt lgkmcnt(0)
    s_lshl3_add_u32 s2, s28, s29
    s_load_dword s30, s[26:27], 0
    s_mov_b32 s78, -1
    s_mov_b32 s79, 0
    s_mov_b32 s52, s4
    s_mov_b32 s53, s5
    s_mov_b32 s54, 2048
    s_mov_b32 s55, 0x20000
    s_mov_b32 s56, s26
    s_mov_b32 s57, s27
    s_mov_b32 s58, 2097152
    s_mov_b32 s59, 0x20000
L_comm:
    v_mov_b32 v8, 0
    v_mov_b32 v20, 0
    v_mov_b32 v21, 0
    v_mov_b32 v22, 0
    v_mov_b32 v23, 0
    ds_write_b128 v8, v[20:23] offset:46368
    ds_write_b128 v8, v[20:23] offset:46384
    ds_write_b128 v8, v[20:23] offset:46400
    ds_write_b128 v8, v[20:23] offset:46416
    ds_write_b128 v8, v[20:23] offset:46432
    ds_write_b128 v8, v[20:23] offset:46448
    s_waitcnt lgkmcnt(0)
    s_barrier
    s_lshl_b32 s31, s29, 8
    s_and_b32 s75, s28, 3
    s_lshl_b32 s75, s75, 6
    s_add_u32 s75, s75, s31
    v_and_b32 v37, 7, v1
    v_lshlrev_b32 v38, 3, v37
    buffer_load_dwordx2 v[10:11], v38, s[52:55], s75 offen
    v_and_b32 v12, 1, v3
    v_lshrrev_b32 v13, 1, v3
    v_cmp_eq_u32 vcc, 1, v12
    v_mov_b32 v14, 0xffff
    v_mov_b32 v15, 0xffff0000
    v_cndmask_b32 v14, v14, v15, vcc
    v_cmp_eq_u32 vcc, 0, v13
    s_nop 1
    v_cndmask_b32 v120, 0, v14, vcc
    v_cmp_eq_u32 vcc, 1, v13
    s_nop 1
    v_cndmask_b32 v121, 0, v14, vcc
    v_cmp_eq_u32 vcc, 2, v13
    s_nop 1
    v_cndmask_b32 v122, 0, v14, vcc
    v_cmp_eq_u32 vcc, 3, v13
    s_nop 1
    v_cndmask_b32 v123, 0, v14, vcc
    s_mov_b32 s68, s22
    s_mov_b32 s69, s23
    s_mov_b32 s70, 2048
    s_mov_b32 s71, 0x20000
    v_lshlrev_b32 v9, 3, v1
    s_lshl_b32 s31, s2, 10
    s_add_u32 s40, s31, 4096
    s_lshl_b32 s31, s28, 13
    s_add_u32 s41, s31, 4096
    s_add_u32 s42, s41, 4096
    s_waitcnt lgkmcnt(0)
    s_add_u32 s30, s30, 1
    v_mov_b32 v13, s30
    v_mov_b32 v15, s30
    v_mov_b32 v17, s30
    v_mov_b32 v19, s30
    s_nop 2
L_fl:
    ds_read_b128 v[20:23], v8 offset:46368
    s_waitcnt lgkmcnt(0)
    v_and_b32 v20, v20, v21
    v_and_b32 v22, v22, v23
    v_and_b32 v20, v20, v22
    s_nop 0
    v_readfirstlane_b32 s31, v20
    s_nop 3
    s_cmp_eq_u32 s31, 1
    s_cbranch_scc1 L_fl_ok
    s_sleep 1
    s_branch L_fl
L_fl_ok:
    ds_read_b64 v[20:21], v9 offset:32768
    ds_read_b64 v[22:23], v9 offset:33280
    ds_read_b64 v[24:25], v9 offset:33792
    ds_read_b64 v[26:27], v9 offset:34304
    s_waitcnt lgkmcnt(0)
    v_add_f32 v12, v20, v22
    v_add_f32 v14, v21, v23
    v_add_f32 v24, v24, v26
    v_add_f32 v25, v25, v27
    v_add_f32 v12, v12, v24
    v_add_f32 v14, v14, v25
    s_getreg_b32 s65, hwreg(HW_REG_XCC_ID)
    s_and_b32 s65, s65, 15
    s_lshl_b32 s65, s65, 28
    s_and_b32 s31, s30, 0xfffffff
    s_or_b32 s65, s65, s31
    v_mov_b32 v13, s65
    v_mov_b32 v15, s65
    buffer_store_dwordx4 v[12:15], v6, s[56:59], s40 offen
    s_mov_b32 s36, s20
    s_mov_b32 s37, s21
    s_mov_b32 s38, 7340032
    s_mov_b32 s39, 0x20000
    v_lshl_add_u32 v58, v2, 11, v7
    s_mul_i32 s35, s28, 229376
    s_lshl_b32 s31, s29, 8
    s_add_u32 s35, s35, s31
    buffer_load_dwordx4 v[128:131], v58, s[36:39], s35 offen nt
    s_add_u32 s35, s35, 8192
    buffer_load_dwordx4 v[132:135], v58, s[36:39], s35 offen nt
    s_add_u32 s35, s35, 8192
    buffer_load_dwordx4 v[136:139], v58, s[36:39], s35 offen nt
    s_add_u32 s35, s35, 8192
    buffer_load_dwordx4 v[140:143], v58, s[36:39], s35 offen nt
    s_add_u32 s35, s35, 8192
    buffer_load_dwordx4 v[144:147], v58, s[36:39], s35 offen nt
    s_add_u32 s35, s35, 8192
    buffer_load_dwordx4 v[148:151], v58, s[36:39], s35 offen nt
    s_add_u32 s35, s35, 8192
    buffer_load_dwordx4 v[152:155], v58, s[36:39], s35 offen nt
    s_add_u32 s35, s35, 8192
    buffer_load_dwordx4 v[156:159], v58, s[36:39], s35 offen nt
    s_add_u32 s35, s35, 8192
    buffer_load_dwordx4 v[160:163], v58, s[36:39], s35 offen nt
    s_add_u32 s35, s35, 8192
    buffer_load_dwordx4 v[164:167], v58, s[36:39], s35 offen nt
    s_add_u32 s35, s35, 8192
    buffer_load_dwordx4 v[168:171], v58, s[36:39], s35 offen nt
    s_add_u32 s35, s35, 8192
    buffer_load_dwordx4 v[172:175], v58, s[36:39], s35 offen nt
    s_add_u32 s35, s35, 8192
    buffer_load_dwordx4 v[176:179], v58, s[36:39], s35 offen nt
    s_add_u32 s35, s35, 8192
    buffer_load_dwordx4 v[180:183], v58, s[36:39], s35 offen nt
    s_add_u32 s35, s35, 8192
    buffer_load_dwordx4 v[184:187], v58, s[36:39], s35 offen nt
    s_add_u32 s35, s35, 8192
    buffer_load_dwordx4 v[188:191], v58, s[36:39], s35 offen nt
    s_add_u32 s35, s35, 8192
    buffer_load_dwordx4 v[192:195], v58, s[36:39], s35 offen nt
    s_add_u32 s35, s35, 8192
    buffer_load_dwordx4 v[196:199], v58, s[36:39], s35 offen nt
    s_add_u32 s35, s35, 8192
    buffer_load_dwordx4 v[200:203], v58, s[36:39], s35 offen nt
    s_add_u32 s35, s35, 8192
    buffer_load_dwordx4 v[204:207], v58, s[36:39], s35 offen nt
    s_add_u32 s35, s35, 8192
    buffer_load_dwordx4 v[208:211], v58, s[36:39], s35 offen nt
    s_add_u32 s35, s35, 8192
    buffer_load_dwordx4 v[212:215], v58, s[36:39], s35 offen nt
    s_add_u32 s35, s35, 8192
    buffer_load_dwordx4 v[216:219], v58, s[36:39], s35 offen nt
    s_add_u32 s35, s35, 8192
    buffer_load_dwordx4 v[220:223], v58, s[36:39], s35 offen nt
    s_add_u32 s35, s35, 8192
    buffer_load_dwordx4 v[224:227], v58, s[36:39], s35 offen nt
    s_add_u32 s35, s35, 8192
    buffer_load_dwordx4 v[228:231], v58, s[36:39], s35 offen nt
    s_add_u32 s35, s35, 8192
    buffer_load_dwordx4 v[232:235], v58, s[36:39], s35 offen nt
    s_add_u32 s35, s35, 8192
    buffer_load_dwordx4 v[236:239], v58, s[36:39], s35 offen nt
    s_add_u32 s35, s35, 8192
    s_mov_b32 s77, 0x100000
    s_mov_b32 s76, 255
L_p0:
    s_bitcmp1_b32 s76, 0
    s_cbranch_scc0 L_p0_s0
    buffer_load_dwordx4 v[64:67], v6, s[56:59], s41 offen offset:0 sc1 nt
L_p0_s0:
    s_bitcmp1_b32 s76, 1
    s_cbranch_scc0 L_p0_s1
    buffer_load_dwordx4 v[68:71], v6, s[56:59], s41 offen offset:1024 sc1 nt
L_p0_s1:
    s_bitcmp1_b32 s76, 2
    s_cbranch_scc0 L_p0_s2
    buffer_load_dwordx4 v[72:75], v6, s[56:59], s41 offen offset:2048 sc1 nt
L_p0_s2:
    s_bitcmp1_b32 s76, 3
    s_cbranch_scc0 L_p0_s3
    buffer_load_dwordx4 v[76:79], v6, s[56:59], s41 offen offset:3072 sc1 nt
L_p0_s3:
    s_bitcmp1_b32 s76, 4
    s_cbranch_scc0 L_p0_s4
    buffer_load_dwordx4 v[80:83], v6, s[56:59], s42 offen offset:0 sc1 nt
L_p0_s4:
    s_bitcmp1_b32 s76, 5
    s_cbranch_scc0 L_p0_s5
    buffer_load_dwordx4 v[84:87], v6, s[56:59], s42 offen offset:1024 sc1 nt
L_p0_s5:
    s_bitcmp1_b32 s76, 6
    s_cbranch_scc0 L_p0_s6
    buffer_load_dwordx4 v[88:91], v6, s[56:59], s42 offen offset:2048 sc1 nt
L_p0_s6:
    s_bitcmp1_b32 s76, 7
    s_cbranch_scc0 L_p0_s7
    buffer_load_dwordx4 v[92:95], v6, s[56:59], s42 offen offset:3072 sc1 nt
L_p0_s7:
    s_waitcnt vmcnt(0)
    v_xor_b32 v250, s65, v65
    v_bitop3_b32 v250, v67, s65, v250 bitop3:0xbe
    v_and_b32 v250, 0xfffffff, v250
    v_cmp_ne_u32 s[4:5], 0, v250
    v_xor_b32 v250, s65, v69
    v_bitop3_b32 v250, v71, s65, v250 bitop3:0xbe
    v_and_b32 v250, 0xfffffff, v250
    v_cmp_ne_u32 s[6:7], 0, v250
    v_xor_b32 v250, s65, v73
    v_bitop3_b32 v250, v75, s65, v250 bitop3:0xbe
    v_and_b32 v250, 0xfffffff, v250
    v_cmp_ne_u32 s[8:9], 0, v250
    v_xor_b32 v250, s65, v77
    v_bitop3_b32 v250, v79, s65, v250 bitop3:0xbe
    v_and_b32 v250, 0xfffffff, v250
    v_cmp_ne_u32 s[10:11], 0, v250
    v_xor_b32 v250, s65, v81
    v_bitop3_b32 v250, v83, s65, v250 bitop3:0xbe
    v_and_b32 v250, 0xfffffff, v250
    v_cmp_ne_u32 s[12:13], 0, v250
    v_xor_b32 v250, s65, v85
    v_bitop3_b32 v250, v87, s65, v250 bitop3:0xbe
    v_and_b32 v250, 0xfffffff, v250
    v_cmp_ne_u32 s[14:15], 0, v250
    v_xor_b32 v250, s65, v89
    v_bitop3_b32 v250, v91, s65, v250 bitop3:0xbe
    v_and_b32 v250, 0xfffffff, v250
    v_cmp_ne_u32 s[16:17], 0, v250
    v_xor_b32 v250, s65, v93
    v_bitop3_b32 v250, v95, s65, v250 bitop3:0xbe
    v_and_b32 v250, 0xfffffff, v250
    v_cmp_ne_u32 s[18:19], 0, v250
    s_mov_b32 s76, 0
    s_cmp_lg_u64 s[4:5], 0
    s_cselect_b32 s74, 1, 0
    s_or_b32 s76, s76, s74
    s_cmp_lg_u64 s[6:7], 0
    s_cselect_b32 s74, 2, 0
    s_or_b32 s76, s76, s74
    s_cmp_lg_u64 s[8:9], 0
    s_cselect_b32 s74, 4, 0
    s_or_b32 s76, s76, s74
    s_cmp_lg_u64 s[10:11], 0
    s_cselect_b32 s74, 8, 0
    s_or_b32 s76, s76, s74
    s_cmp_lg_u64 s[12:13], 0
    s_cselect_b32 s74, 16, 0
    s_or_b32 s76, s76, s74
    s_cmp_lg_u64 s[14:15], 0
    s_cselect_b32 s74, 32, 0
    s_or_b32 s76, s76, s74
    s_cmp_lg_u64 s[16:17], 0
    s_cselect_b32 s74, 64, 0
    s_or_b32 s76, s76, s74
    s_cmp_lg_u64 s[18:19], 0
    s_cselect_b32 s74, 128, 0
    s_or_b32 s76, s76, s74
    s_cmp_eq_u32 s76, 0
    s_cbranch_scc1 L_p0_ok
    s_cmp_lg_u32 s77, 1048568
    s_cbranch_scc1 L_p0_nh
    buffer_store_dwordx4 v[12:15], v6, s[56:59], s40 offen sc1
L_p0_nh:
    s_sub_u32 s77, s77, 1
    s_cmp_eq_u32 s77, 0
    s_cbranch_scc1 L_p0_ok
    s_sleep 1
    s_branch L_p0
L_p0_ok:
    v_xor_b32 v250, s65, v65
    v_bitop3_b32 v250, v69, s65, v250 bitop3:0xbe
    v_bitop3_b32 v250, v73, s65, v250 bitop3:0xbe
    v_bitop3_b32 v250, v77, s65, v250 bitop3:0xbe
    v_bitop3_b32 v250, v81, s65, v250 bitop3:0xbe
    v_bitop3_b32 v250, v85, s65, v250 bitop3:0xbe
    v_bitop3_b32 v250, v89, s65, v250 bitop3:0xbe
    v_bitop3_b32 v250, v93, s65, v250 bitop3:0xbe
    v_cmp_ne_u32 vcc, 0, v250
    s_nop 3
    s_cmp_eq_u64 vcc, 0
    s_cselect_b32 s11, 1, 0
    s_cbranch_scc1 L_qloc
    buffer_store_dwordx4 v[12:15], v6, s[56:59], s40 offen sc1
L_qloc:
    s_nop 1
    v_mov_b32 v13, s30
    v_mov_b32 v15, s30
    v_add_f32 v64, v64, v68
    v_add_f32 v72, v72, v76
    v_add_f32 v80, v80, v84
    v_add_f32 v88, v88, v92
    v_add_f32 v64, v64, v72
    v_add_f32 v80, v80, v88
    v_add_f32 v64, v64, v80
    v_add_f32 v66, v66, v70
    v_add_f32 v74, v74, v78
    v_add_f32 v82, v82, v86
    v_add_f32 v90, v90, v94
    v_add_f32 v66, v66, v74
    v_add_f32 v82, v82, v90
    v_add_f32 v66, v66, v82
    v_cvt_pk_bf16_f32 v64, v64, v66
    v_lshlrev_b32 v20, 2, v1
    ds_write_b32 v20, v64 offset:45056
    v_mov_b32 v20, 1
    ds_write_b32 v8, v20 offset:46400
    s_nop 1
L_fg:
    ds_read_b128 v[20:23], v8 offset:46384
    s_waitcnt lgkmcnt(0)
    v_and_b32 v20, v20, v21
    v_and_b32 v22, v22, v23
    v_and_b32 v20, v20, v22
    s_nop 0
    v_readfirstlane_b32 s31, v20
    s_nop 3
    s_cmp_eq_u32 s31, 1
    s_cbranch_scc1 L_fg_ok
    s_sleep 2
    s_branch L_fg
L_fg_ok:
    s_mov_b32 s61, 0xff
    ds_read_b64 v[20:21], v9 offset:34816
    ds_read_b64 v[22:23], v9 offset:35328
    ds_read_b64 v[24:25], v9 offset:35840
    ds_read_b64 v[26:27], v9 offset:36352
    ds_read_b64 v[28:29], v9 offset:36864
    ds_read_b64 v[30:31], v9 offset:37376
    ds_read_b64 v[32:33], v9 offset:37888
    ds_read_b64 v[34:35], v9 offset:38400
    s_waitcnt lgkmcnt(0)
    v_add_f32 v16, v20, v22
    v_add_f32 v17, v21, v23
    v_add_f32 v24, v24, v26
    v_add_f32 v25, v25, v27
    v_add_f32 v16, v16, v24
    v_add_f32 v17, v17, v25
    v_add_f32 v18, v28, v30
    v_add_f32 v19, v29, v31
    v_add_f32 v32, v32, v34
    v_add_f32 v33, v33, v35
    v_add_f32 v18, v18, v32
    v_add_f32 v19, v19, v33
    v_bfi_b32 v16, s61, v13, v16
    v_bfi_b32 v17, s61, v13, v17
    v_bfi_b32 v18, s61, v13, v18
    v_bfi_b32 v19, s61, v13, v19
    s_lshl_b32 s43, s2, 10
    s_add_u32 s40, s43, 327680
    s_mov_b32 s62, -1
    s_mov_b32 s63, 0xffffff
    s_mov_b64 exec, s[62:63]
    s_cmp_eq_u32 s11, 1
    s_cbranch_scc1 L_gs_l
    buffer_store_dwordx4 v[16:19], v6, s[56:59], s40 offen sc1
    s_branch L_gs_e
L_gs_l:
    buffer_store_dwordx4 v[16:19], v6, s[56:59], s40 offen
L_gs_e:
    s_mov_b64 exec, -1
    v_lshlrev_b32 v50, 7, v1
    s_mov_b32 s44, 1
    s_mov_b32 s45, 3
    s_mov_b32 s46, 4
    s_mov_b32 s47, 0
    s_mov_b32 s51, 0
    s_mov_b32 s52, 0
    s_mov_b32 s53, 0
    s_mov_b32 s54, 0
    s_lshr_b32 s55, s2, 4
    s_xor_b32 s55, s55, s2
    s_and_b32 s55, s55, 15
    v_and_b32 v50, 15, v1
    v_lshlrev_b32 v50, 7, v50
    s_lshr_b32 s48, s2, 4
    s_lshl_b32 s48, s48, 7
    s_add_u32 s48, s48, 1900544
    s_mov_b32 s49, 1900544
    s_lshr_b32 s50, s28, 2
    s_lshl_b32 s50, s50, 7
    s_add_u32 s50, s50, 2031616
    s_mov_b32 s60, 2031616
    s_cmp_eq_u32 s2, 0
    s_cselect_b32 s45, s45, -1
    s_mov_b32 s4, 0
    s_mov_b32 s5, 0
    s_mov_b32 s6, 0
    s_mov_b32 s7, 0
    s_mov_b32 s10, 2
L_ctl:
    ds_read_b128 v[20:23], v8 offset:46432
    ds_read_b128 v[24:27], v8 offset:46448
    s_waitcnt lgkmcnt(0)
    v_min_u32 v21, v21, v23
    v_min3_u32 v21, v21, v25, v27
    s_nop 0
    v_readfirstlane_b32 s31, v21
    s_cmp_eq_u32 s10, -1
    s_cbranch_scc0 L_ctl_c
    s_nop 1
    s_cmp_ge_u32 s31, 60
    s_cbranch_scc1 L_ctl_end
L_ctl_c:
    s_cmp_eq_u32 s31, s47
    s_cbranch_scc1 L_ctl_sleep
    s_mov_b32 s47, s31
    v_sub_u32 v22, v22, v20
    v_sub_u32 v24, v24, v20
    v_sub_u32 v26, v26, v20
    v_add3_u32 v22, v22, v24, v26
    v_ashrrev_i32 v22, 2, v22
    v_add_u32 v12, v20, v22
    s_cmp_lt_u32 s47, s44
    s_cbranch_scc1 L_ctl_g
    s_mov_b32 s6, 0
    s_cmp_eq_u32 s44, 1
    s_cselect_b32 s9, 5, 8
    s_add_u32 s44, s44, s9
    s_cmp_lg_u32 s55, 0
    s_cbranch_scc1 L_ctl_g
    s_mov_b64 exec, 1
    buffer_store_dwordx2 v[12:13], v8, s[56:59], s48 offen sc1
    s_mov_b64 exec, -1
    s_add_u32 s48, s48, 8192
L_ctl_g:
    s_cmp_lt_u32 s47, s45
    s_cbranch_scc1 L_ctl_rd
    buffer_load_dwordx2 v[20:21], v50, s[56:59], s49 offen sc1
    s_waitcnt vmcnt(0)
    v_cmp_ne_u32 vcc, s30, v21
    s_nop 3
    s_cmp_lg_u64 vcc, 0
    s_cbranch_scc1 L_ctl_rd
    v_sub_u32 v20, v20, v12
    v_mov_b32 v22, v20
    s_nop 1
    v_max_i32_dpp v22, v22, v22 row_ror:8 row_mask:0xf bank_mask:0xf
    s_nop 1
    v_max_i32_dpp v22, v22, v22 row_ror:4 row_mask:0xf bank_mask:0xf
    s_nop 1
    v_max_i32_dpp v22, v22, v22 row_ror:2 row_mask:0xf bank_mask:0xf
    s_nop 1
    v_max_i32_dpp v22, v22, v22 row_ror:1 row_mask:0xf bank_mask:0xf
    v_mov_b32 v21, v22
    s_nop 1
    v_permlane16_swap_b32 v22, v21
    v_max_i32 v22, v22, v21
    v_mov_b32 v21, v22
    s_nop 1
    v_permlane32_swap_b32 v22, v21
    v_max_i32 v22, v22, v21
    v_add_u32_dpp v20, v20, v20 row_ror:8 row_mask:0xf bank_mask:0xf
    s_nop 1
    v_add_u32_dpp v20, v20, v20 row_ror:4 row_mask:0xf bank_mask:0xf
    s_nop 1
    v_add_u32_dpp v20, v20, v20 row_ror:2 row_mask:0xf bank_mask:0xf
    s_nop 1
    v_add_u32_dpp v20, v20, v20 row_ror:1 row_mask:0xf bank_mask:0xf
    v_mov_b32 v21, v20
    s_nop 1
    v_permlane16_swap_b32 v20, v21
    v_add_u32 v20, v20, v21
    v_mov_b32 v21, v20
    s_nop 1
    v_permlane32_swap_b32 v20, v21
    v_add_u32 v20, v20, v21
    v_ashrrev_i32 v20, 6, v20
    s_cmp_gt_u32 s45, 8
    s_cselect_b32 s9, 50, 0x100000
    v_sub_u32 v22, v22, v20
    v_subrev_u32 v22, s9, v22
    v_max_i32 v22, 0, v22
    v_ashrrev_i32 v22, 1, v22
    v_add_u32 v20, v20, v22
    v_add_u32 v14, v12, v20
    s_mov_b64 exec, 0xff
    buffer_store_dwordx2 v[14:15], v50, s[56:59], s60 offen sc1
    s_mov_b64 exec, -1
    s_cmp_eq_u32 s45, 3
    s_cselect_b32 s9, 5, 8
    s_add_u32 s45, s45, s9
    s_add_u32 s49, s49, 8192
    s_add_u32 s60, s60, 1024
L_ctl_rd:
    s_cmp_lt_u32 s47, s46
    s_cbranch_scc1 L_ctl_up
    s_cmp_eq_u32 s47, s46
    s_cbranch_scc1 L_ctl_r1
    s_mov_b64 exec, 1
    buffer_load_dwordx2 v[28:29], v8, s[56:59], s50 offen sc1
    s_waitcnt vmcnt(0)
    v_readfirstlane_b32 s65, v29
    v_readfirstlane_b32 s64, v28
    s_mov_b64 exec, -1
    s_nop 3
    s_branch L_ctl_r2
L_ctl_r1:
    s_load_dwordx2 s[64:65], s[26:27], s50
    s_waitcnt lgkmcnt(0)
L_ctl_r2:
    s_mov_b32 s31, s65
    s_cmp_lg_u32 s31, s30
    s_cbranch_scc1 L_ctl_up
    s_add_u32 s64, s64, s6
    s_sub_u32 s52, s64, s51
    s_and_b32 s52, s52, s54
    s_mov_b32 s9, s52
    s_min_i32 s52, s52, s7
    s_mov_b32 s7, s9
    s_cmp_lt_i32 s52, 40
    s_cselect_b32 s52, 0, s52
    s_mov_b32 s51, s64
    s_sub_u32 s53, s46, 4
    s_mov_b32 s54, -1
    s_cmp_eq_u32 s46, 4
    s_cselect_b32 s9, 5, 8
    s_add_u32 s46, s46, s9
    s_add_u32 s50, s50, 1024
L_ctl_up:
    s_sub_u32 s31, s47, s53
    s_mul_i32 s31, s31, s52
    s_ashr_i32 s31, s31, 3
    s_add_u32 s31, s31, s51
    v_mov_b32 v30, s31
    v_mov_b32 v31, s54
    ds_write_b64 v8, v[30:31] offset:46416
    s_cmp_lt_u32 s47, s10
    s_cbranch_scc1 L_ctl_sleep
    s_mov_b32 s10, -1
    s_lshl_b32 s31, s28, 13
    s_add_u32 s18, s31, 327680
    s_add_u32 s19, s18, 4096
    s_mov_b64 exec, s[62:63]
    s_mov_b32 s77, 1048576
    s_and_b32 s74, s30, 0xff
L_pg:
    buffer_load_dwordx4 v[64:67], v6, s[56:59], s18 offen offset:0 sc1 nt
    buffer_load_dwordx4 v[68:71], v6, s[56:59], s18 offen offset:1024 sc1 nt
    buffer_load_dwordx4 v[72:75], v6, s[56:59], s18 offen offset:2048 sc1 nt
    buffer_load_dwordx4 v[76:79], v6, s[56:59], s18 offen offset:3072 sc1 nt
    buffer_load_dwordx4 v[80:83], v6, s[56:59], s19 offen offset:0 sc1 nt
    buffer_load_dwordx4 v[84:87], v6, s[56:59], s19 offen offset:1024 sc1 nt
    buffer_load_dwordx4 v[88:91], v6, s[56:59], s19 offen offset:2048 sc1 nt
    buffer_load_dwordx4 v[92:95], v6, s[56:59], s19 offen offset:3072 sc1 nt
    s_waitcnt vmcnt(0)
    v_xor_b32 v64, s74, v64
    v_xor_b32 v65, s74, v65
    v_xor_b32 v66, s74, v66
    v_xor_b32 v67, s74, v67
    v_xor_b32 v68, s74, v68
    v_xor_b32 v69, s74, v69
    v_xor_b32 v70, s74, v70
    v_xor_b32 v71, s74, v71
    v_xor_b32 v72, s74, v72
    v_xor_b32 v73, s74, v73
    v_xor_b32 v74, s74, v74
    v_xor_b32 v75, s74, v75
    v_xor_b32 v76, s74, v76
    v_xor_b32 v77, s74, v77
    v_xor_b32 v78, s74, v78
    v_xor_b32 v79, s74, v79
    v_xor_b32 v80, s74, v80
    v_xor_b32 v81, s74, v81
    v_xor_b32 v82, s74, v82
    v_xor_b32 v83, s74, v83
    v_xor_b32 v84, s74, v84
    v_xor_b32 v85, s74, v85
    v_xor_b32 v86, s74, v86
    v_xor_b32 v87, s74, v87
    v_xor_b32 v88, s74, v88
    v_xor_b32 v89, s74, v89
    v_xor_b32 v90, s74, v90
    v_xor_b32 v91, s74, v91
    v_xor_b32 v92, s74, v92
    v_xor_b32 v93, s74, v93
    v_xor_b32 v94, s74, v94
    v_xor_b32 v95, s74, v95
    v_or_b32 v250, v64, v65
    v_or3_b32 v250, v250, v66, v67
    v_or3_b32 v250, v250, v68, v69
    v_or3_b32 v250, v250, v70, v71
    v_or3_b32 v250, v250, v72, v73
    v_or3_b32 v250, v250, v74, v75
    v_or3_b32 v250, v250, v76, v77
    v_or3_b32 v250, v250, v78, v79
    v_or3_b32 v250, v250, v80, v81
    v_or3_b32 v250, v250, v82, v83
    v_or3_b32 v250, v250, v84, v85
    v_or3_b32 v250, v250, v86, v87
    v_or3_b32 v250, v250, v88, v89
    v_or3_b32 v250, v250, v90, v91
    v_or3_b32 v250, v250, v92, v93
    v_or3_b32 v250, v250, v94, v95
    v_and_b32 v250, 0xff, v250
    v_cmp_ne_u32 vcc, 0, v250
    s_nop 3
    s_cmp_eq_u64 vcc, 0
    s_cbranch_scc1 L_pg_ok
    s_sub_u32 s77, s77, 1
    s_cmp_eq_u32 s77, 0
    s_cbranch_scc1 L_pg_ok
    s_sleep 50
    s_branch L_pg
L_pg_ok:
    s_mov_b64 exec, -1
    v_add_f32 v64, v64, v68
    v_add_f32 v72, v72, v76
    v_add_f32 v80, v80, v84
    v_add_f32 v88, v88, v92
    v_add_f32 v64, v64, v72
    v_add_f32 v80, v80, v88
    v_add_f32 v64, v64, v80
    v_add_f32 v65, v65, v69
    v_add_f32 v73, v73, v77
    v_add_f32 v81, v81, v85
    v_add_f32 v89, v89, v93
    v_add_f32 v65, v65, v73
    v_add_f32 v81, v81, v89
    v_add_f32 v65, v65, v81
    v_add_f32 v66, v66, v70
    v_add_f32 v74, v74, v78
    v_add_f32 v82, v82, v86
    v_add_f32 v90, v90, v94
    v_add_f32 v66, v66, v74
    v_add_f32 v82, v82, v90
    v_add_f32 v66, v66, v82
    v_add_f32 v67, v67, v71
    v_add_f32 v75, v75, v79
    v_add_f32 v83, v83, v87
    v_add_f32 v91, v91, v95
    v_add_f32 v67, v67, v75
    v_add_f32 v83, v83, v91
    v_add_f32 v67, v67, v83
    v_cvt_pk_bf16_f32 v64, v64, v64
    v_and_b32 v64, 0xffff0000, v64
    v_cvt_pk_bf16_f32 v65, v65, v65
    v_and_b32 v65, 0xffff0000, v65
    v_cvt_pk_bf16_f32 v66, v66, v66
    v_and_b32 v66, 0xffff0000, v66
    v_cvt_pk_bf16_f32 v67, v67, v67
    v_and_b32 v67, 0xffff0000, v67
    s_mov_b32 s16, 0x3d372713
    s_mov_b32 s17, 0xc0135761
    v_mul_f32 v20, v64, v64
    v_fma_f32 v20, v20, s16, 1.0
    v_mul_f32 v20, v20, v64
    v_mul_f32 v20, s17, v20
    v_exp_f32 v20, v20
    s_nop 0
    v_add_f32 v20, 1.0, v20
    v_rcp_f32 v20, v20
    s_nop 0
    v_mul_f32 v64, v64, v20
    v_cvt_pk_bf16_f32 v64, v64, v64
    v_and_b32 v64, 0xffff0000, v64
    v_mul_f32 v64, v64, v66
    v_mul_f32 v20, v65, v65
    v_fma_f32 v20, v20, s16, 1.0
    v_mul_f32 v20, v20, v65
    v_mul_f32 v20, s17, v20
    v_exp_f32 v20, v20
    s_nop 0
    v_add_f32 v20, 1.0, v20
    v_rcp_f32 v20, v20
    s_nop 0
    v_mul_f32 v65, v65, v20
    v_cvt_pk_bf16_f32 v65, v65, v65
    v_and_b32 v65, 0xffff0000, v65
    v_mul_f32 v65, v65, v67
    v_cvt_pk_bf16_f32 v20, v64, v64
    v_cvt_pk_bf16_f32 v21, v65, v65
    ds_write_b64 v9, v[20:21] offset:45312
    v_lshl_add_u32 v20, v2, 2, v7
    ds_read_b32 v56, v20 offset:45312
    ds_read_b32 v57, v20 offset:45568
    s_waitcnt lgkmcnt(0)
    v_and_b32_dpp v24, v56, v120 row_newbcast:0 row_mask:0xf bank_mask:0xf
    v_and_b32_dpp v25, v56, v121 row_newbcast:0 row_mask:0xf bank_mask:0xf
    v_and_b32_dpp v26, v56, v122 row_newbcast:0 row_mask:0xf bank_mask:0xf
    v_and_b32_dpp v27, v56, v123 row_newbcast:0 row_mask:0xf bank_mask:0xf
    v_and_b32_dpp v28, v56, v120 row_newbcast:1 row_mask:0xf bank_mask:0xf
    v_and_b32_dpp v29, v56, v121 row_newbcast:1 row_mask:0xf bank_mask:0xf
    v_and_b32_dpp v30, v56, v122 row_newbcast:1 row_mask:0xf bank_mask:0xf
    v_and_b32_dpp v31, v56, v123 row_newbcast:1 row_mask:0xf bank_mask:0xf
    v_mfma_f32_16x16x32_bf16 v[52:55], v[24:27], v[128:131], 0
    v_and_b32_dpp v24, v56, v120 row_newbcast:2 row_mask:0xf bank_mask:0xf
    v_and_b32_dpp v25, v56, v121 row_newbcast:2 row_mask:0xf bank_mask:0xf
    v_and_b32_dpp v26, v56, v122 row_newbcast:2 row_mask:0xf bank_mask:0xf
    v_and_b32_dpp v27, v56, v123 row_newbcast:2 row_mask:0xf bank_mask:0xf
    v_mfma_f32_16x16x32_bf16 v[52:55], v[28:31], v[132:135], v[52:55]
    v_and_b32_dpp v28, v56, v120 row_newbcast:3 row_mask:0xf bank_mask:0xf
    v_and_b32_dpp v29, v56, v121 row_newbcast:3 row_mask:0xf bank_mask:0xf
    v_and_b32_dpp v30, v56, v122 row_newbcast:3 row_mask:0xf bank_mask:0xf
    v_and_b32_dpp v31, v56, v123 row_newbcast:3 row_mask:0xf bank_mask:0xf
    v_mfma_f32_16x16x32_bf16 v[52:55], v[24:27], v[136:139], v[52:55]
    v_and_b32_dpp v24, v56, v120 row_newbcast:4 row_mask:0xf bank_mask:0xf
    v_and_b32_dpp v25, v56, v121 row_newbcast:4 row_mask:0xf bank_mask:0xf
    v_and_b32_dpp v26, v56, v122 row_newbcast:4 row_mask:0xf bank_mask:0xf
    v_and_b32_dpp v27, v56, v123 row_newbcast:4 row_mask:0xf bank_mask:0xf
    v_mfma_f32_16x16x32_bf16 v[52:55], v[28:31], v[140:143], v[52:55]
    v_and_b32_dpp v28, v56, v120 row_newbcast:5 row_mask:0xf bank_mask:0xf
    v_and_b32_dpp v29, v56, v121 row_newbcast:5 row_mask:0xf bank_mask:0xf
    v_and_b32_dpp v30, v56, v122 row_newbcast:5 row_mask:0xf bank_mask:0xf
    v_and_b32_dpp v31, v56, v123 row_newbcast:5 row_mask:0xf bank_mask:0xf
    v_mfma_f32_16x16x32_bf16 v[52:55], v[24:27], v[144:147], v[52:55]
    v_and_b32_dpp v24, v56, v120 row_newbcast:6 row_mask:0xf bank_mask:0xf
    v_and_b32_dpp v25, v56, v121 row_newbcast:6 row_mask:0xf bank_mask:0xf
    v_and_b32_dpp v26, v56, v122 row_newbcast:6 row_mask:0xf bank_mask:0xf
    v_and_b32_dpp v27, v56, v123 row_newbcast:6 row_mask:0xf bank_mask:0xf
    v_mfma_f32_16x16x32_bf16 v[52:55], v[28:31], v[148:151], v[52:55]
    v_and_b32_dpp v28, v56, v120 row_newbcast:7 row_mask:0xf bank_mask:0xf
    v_and_b32_dpp v29, v56, v121 row_newbcast:7 row_mask:0xf bank_mask:0xf
    v_and_b32_dpp v30, v56, v122 row_newbcast:7 row_mask:0xf bank_mask:0xf
    v_and_b32_dpp v31, v56, v123 row_newbcast:7 row_mask:0xf bank_mask:0xf
    v_mfma_f32_16x16x32_bf16 v[52:55], v[24:27], v[152:155], v[52:55]
    v_and_b32_dpp v24, v56, v120 row_newbcast:8 row_mask:0xf bank_mask:0xf
    v_and_b32_dpp v25, v56, v121 row_newbcast:8 row_mask:0xf bank_mask:0xf
    v_and_b32_dpp v26, v56, v122 row_newbcast:8 row_mask:0xf bank_mask:0xf
    v_and_b32_dpp v27, v56, v123 row_newbcast:8 row_mask:0xf bank_mask:0xf
    v_mfma_f32_16x16x32_bf16 v[52:55], v[28:31], v[156:159], v[52:55]
    v_and_b32_dpp v28, v56, v120 row_newbcast:9 row_mask:0xf bank_mask:0xf
    v_and_b32_dpp v29, v56, v121 row_newbcast:9 row_mask:0xf bank_mask:0xf
    v_and_b32_dpp v30, v56, v122 row_newbcast:9 row_mask:0xf bank_mask:0xf
    v_and_b32_dpp v31, v56, v123 row_newbcast:9 row_mask:0xf bank_mask:0xf
    v_mfma_f32_16x16x32_bf16 v[52:55], v[24:27], v[160:163], v[52:55]
    v_and_b32_dpp v24, v56, v120 row_newbcast:10 row_mask:0xf bank_mask:0xf
    v_and_b32_dpp v25, v56, v121 row_newbcast:10 row_mask:0xf bank_mask:0xf
    v_and_b32_dpp v26, v56, v122 row_newbcast:10 row_mask:0xf bank_mask:0xf
    v_and_b32_dpp v27, v56, v123 row_newbcast:10 row_mask:0xf bank_mask:0xf
    v_mfma_f32_16x16x32_bf16 v[52:55], v[28:31], v[164:167], v[52:55]
    v_and_b32_dpp v28, v56, v120 row_newbcast:11 row_mask:0xf bank_mask:0xf
    v_and_b32_dpp v29, v56, v121 row_newbcast:11 row_mask:0xf bank_mask:0xf
    v_and_b32_dpp v30, v56, v122 row_newbcast:11 row_mask:0xf bank_mask:0xf
    v_and_b32_dpp v31, v56, v123 row_newbcast:11 row_mask:0xf bank_mask:0xf
    v_mfma_f32_16x16x32_bf16 v[52:55], v[24:27], v[168:171], v[52:55]
    v_and_b32_dpp v24, v56, v120 row_newbcast:12 row_mask:0xf bank_mask:0xf
    v_and_b32_dpp v25, v56, v121 row_newbcast:12 row_mask:0xf bank_mask:0xf
    v_and_b32_dpp v26, v56, v122 row_newbcast:12 row_mask:0xf bank_mask:0xf
    v_and_b32_dpp v27, v56, v123 row_newbcast:12 row_mask:0xf bank_mask:0xf
    v_mfma_f32_16x16x32_bf16 v[52:55], v[28:31], v[172:175], v[52:55]
    v_and_b32_dpp v28, v56, v120 row_newbcast:13 row_mask:0xf bank_mask:0xf
    v_and_b32_dpp v29, v56, v121 row_newbcast:13 row_mask:0xf bank_mask:0xf
    v_and_b32_dpp v30, v56, v122 row_newbcast:13 row_mask:0xf bank_mask:0xf
    v_and_b32_dpp v31, v56, v123 row_newbcast:13 row_mask:0xf bank_mask:0xf
    v_mfma_f32_16x16x32_bf16 v[52:55], v[24:27], v[176:179], v[52:55]
    v_and_b32_dpp v24, v56, v120 row_newbcast:14 row_mask:0xf bank_mask:0xf
    v_and_b32_dpp v25, v56, v121 row_newbcast:14 row_mask:0xf bank_mask:0xf
    v_and_b32_dpp v26, v56, v122 row_newbcast:14 row_mask:0xf bank_mask:0xf
    v_and_b32_dpp v27, v56, v123 row_newbcast:14 row_mask:0xf bank_mask:0xf
    v_mfma_f32_16x16x32_bf16 v[52:55], v[28:31], v[180:183], v[52:55]
    v_and_b32_dpp v28, v56, v120 row_newbcast:15 row_mask:0xf bank_mask:0xf
    v_and_b32_dpp v29, v56, v121 row_newbcast:15 row_mask:0xf bank_mask:0xf
    v_and_b32_dpp v30, v56, v122 row_newbcast:15 row_mask:0xf bank_mask:0xf
    v_and_b32_dpp v31, v56, v123 row_newbcast:15 row_mask:0xf bank_mask:0xf
    v_mfma_f32_16x16x32_bf16 v[52:55], v[24:27], v[184:187], v[52:55]
    v_and_b32_dpp v24, v57, v120 row_newbcast:0 row_mask:0xf bank_mask:0xf
    v_and_b32_dpp v25, v57, v121 row_newbcast:0 row_mask:0xf bank_mask:0xf
    v_and_b32_dpp v26, v57, v122 row_newbcast:0 row_mask:0xf bank_mask:0xf
    v_and_b32_dpp v27, v57, v123 row_newbcast:0 row_mask:0xf bank_mask:0xf
    v_mfma_f32_16x16x32_bf16 v[52:55], v[28:31], v[188:191], v[52:55]
    v_and_b32_dpp v28, v57, v120 row_newbcast:1 row_mask:0xf bank_mask:0xf
    v_and_b32_dpp v29, v57, v121 row_newbcast:1 row_mask:0xf bank_mask:0xf
    v_and_b32_dpp v30, v57, v122 row_newbcast:1 row_mask:0xf bank_mask:0xf
    v_and_b32_dpp v31, v57, v123 row_newbcast:1 row_mask:0xf bank_mask:0xf
    v_mfma_f32_16x16x32_bf16 v[52:55], v[24:27], v[192:195], v[52:55]
    v_and_b32_dpp v24, v57, v120 row_newbcast:2 row_mask:0xf bank_mask:0xf
    v_and_b32_dpp v25, v57, v121 row_newbcast:2 row_mask:0xf bank_mask:0xf
    v_and_b32_dpp v26, v57, v122 row_newbcast:2 row_mask:0xf bank_mask:0xf
    v_and_b32_dpp v27, v57, v123 row_newbcast:2 row_mask:0xf bank_mask:0xf
    v_mfma_f32_16x16x32_bf16 v[52:55], v[28:31], v[196:199], v[52:55]
    v_and_b32_dpp v28, v57, v120 row_newbcast:3 row_mask:0xf bank_mask:0xf
    v_and_b32_dpp v29, v57, v121 row_newbcast:3 row_mask:0xf bank_mask:0xf
    v_and_b32_dpp v30, v57, v122 row_newbcast:3 row_mask:0xf bank_mask:0xf
    v_and_b32_dpp v31, v57, v123 row_newbcast:3 row_mask:0xf bank_mask:0xf
    v_mfma_f32_16x16x32_bf16 v[52:55], v[24:27], v[200:203], v[52:55]
    v_and_b32_dpp v24, v57, v120 row_newbcast:4 row_mask:0xf bank_mask:0xf
    v_and_b32_dpp v25, v57, v121 row_newbcast:4 row_mask:0xf bank_mask:0xf
    v_and_b32_dpp v26, v57, v122 row_newbcast:4 row_mask:0xf bank_mask:0xf
    v_and_b32_dpp v27, v57, v123 row_newbcast:4 row_mask:0xf bank_mask:0xf
    v_mfma_f32_16x16x32_bf16 v[52:55], v[28:31], v[204:207], v[52:55]
    v_and_b32_dpp v28, v57, v120 row_newbcast:5 row_mask:0xf bank_mask:0xf
    v_and_b32_dpp v29, v57, v121 row_newbcast:5 row_mask:0xf bank_mask:0xf
    v_and_b32_dpp v30, v57, v122 row_newbcast:5 row_mask:0xf bank_mask:0xf
    v_and_b32_dpp v31, v57, v123 row_newbcast:5 row_mask:0xf bank_mask:0xf
    v_mfma_f32_16x16x32_bf16 v[52:55], v[24:27], v[208:211], v[52:55]
    v_and_b32_dpp v24, v57, v120 row_newbcast:6 row_mask:0xf bank_mask:0xf
    v_and_b32_dpp v25, v57, v121 row_newbcast:6 row_mask:0xf bank_mask:0xf
    v_and_b32_dpp v26, v57, v122 row_newbcast:6 row_mask:0xf bank_mask:0xf
    v_and_b32_dpp v27, v57, v123 row_newbcast:6 row_mask:0xf bank_mask:0xf
    v_mfma_f32_16x16x32_bf16 v[52:55], v[28:31], v[212:215], v[52:55]
    v_and_b32_dpp v28, v57, v120 row_newbcast:7 row_mask:0xf bank_mask:0xf
    v_and_b32_dpp v29, v57, v121 row_newbcast:7 row_mask:0xf bank_mask:0xf
    v_and_b32_dpp v30, v57, v122 row_newbcast:7 row_mask:0xf bank_mask:0xf
    v_and_b32_dpp v31, v57, v123 row_newbcast:7 row_mask:0xf bank_mask:0xf
    v_mfma_f32_16x16x32_bf16 v[52:55], v[24:27], v[216:219], v[52:55]
    v_and_b32_dpp v24, v57, v120 row_newbcast:8 row_mask:0xf bank_mask:0xf
    v_and_b32_dpp v25, v57, v121 row_newbcast:8 row_mask:0xf bank_mask:0xf
    v_and_b32_dpp v26, v57, v122 row_newbcast:8 row_mask:0xf bank_mask:0xf
    v_and_b32_dpp v27, v57, v123 row_newbcast:8 row_mask:0xf bank_mask:0xf
    v_mfma_f32_16x16x32_bf16 v[52:55], v[28:31], v[220:223], v[52:55]
    v_and_b32_dpp v28, v57, v120 row_newbcast:9 row_mask:0xf bank_mask:0xf
    v_and_b32_dpp v29, v57, v121 row_newbcast:9 row_mask:0xf bank_mask:0xf
    v_and_b32_dpp v30, v57, v122 row_newbcast:9 row_mask:0xf bank_mask:0xf
    v_and_b32_dpp v31, v57, v123 row_newbcast:9 row_mask:0xf bank_mask:0xf
    v_mfma_f32_16x16x32_bf16 v[52:55], v[24:27], v[224:227], v[52:55]
    v_and_b32_dpp v24, v57, v120 row_newbcast:10 row_mask:0xf bank_mask:0xf
    v_and_b32_dpp v25, v57, v121 row_newbcast:10 row_mask:0xf bank_mask:0xf
    v_and_b32_dpp v26, v57, v122 row_newbcast:10 row_mask:0xf bank_mask:0xf
    v_and_b32_dpp v27, v57, v123 row_newbcast:10 row_mask:0xf bank_mask:0xf
    v_mfma_f32_16x16x32_bf16 v[52:55], v[28:31], v[228:231], v[52:55]
    v_and_b32_dpp v28, v57, v120 row_newbcast:11 row_mask:0xf bank_mask:0xf
    v_and_b32_dpp v29, v57, v121 row_newbcast:11 row_mask:0xf bank_mask:0xf
    v_and_b32_dpp v30, v57, v122 row_newbcast:11 row_mask:0xf bank_mask:0xf
    v_and_b32_dpp v31, v57, v123 row_newbcast:11 row_mask:0xf bank_mask:0xf
    v_mfma_f32_16x16x32_bf16 v[52:55], v[24:27], v[232:235], v[52:55]
    s_nop 0
    v_mfma_f32_16x16x32_bf16 v[52:55], v[28:31], v[236:239], v[52:55]
    s_nop 7
    v_bfi_b32 v52, s61, v13, v52
    v_bfi_b32 v53, s61, v13, v53
    v_bfi_b32 v54, s61, v13, v54
    v_bfi_b32 v55, s61, v13, v55
    s_nop 2
L_ctl_sleep:
    s_sleep 8
    s_branch L_ctl
L_ctl_end:
    ds_read_b128 v[44:47], v8 offset:46336
    s_waitcnt lgkmcnt(0)
    v_max_f32 v20, v44, v45
    v_max3_f32 v16, v20, v46, v47
    s_mov_b32 s31, 1069066811
    v_sub_f32 v44, v44, v16
    v_mul_f32 v44, s31, v44
    v_exp_f32 v44, v44
    v_sub_f32 v45, v45, v16
    v_mul_f32 v45, s31, v45
    v_exp_f32 v45, v45
    v_sub_f32 v46, v46, v16
    v_mul_f32 v46, s31, v46
    v_exp_f32 v46, v46
    v_sub_f32 v47, v47, v16
    v_mul_f32 v47, s31, v47
    v_exp_f32 v47, v47
    s_add_u32 s40, s43, 589824
    s_lshl_b32 s31, s2, 9
    s_add_u32 s41, s31, 851968
    s_add_u32 s42, s31, 983040
    v_lshlrev_b32 v39, 5, v3
    v_lshl_add_u32 v39, v2, 4, v39
    v_cmp_eq_u32 vcc, 32, v1
    v_mov_b32 v20, 2048
    s_nop 0
    v_cndmask_b32 v48, v6, v20, vcc
    v_cndmask_b32 v49, 0, v16, vcc
    v_mov_b32 v20, 0xff
    v_cndmask_b32 v51, v20, -1, vcc
    s_mov_b32 s63, 1
    v_lshrrev_b32 v36, 3, v1
    v_lshlrev_b32 v36, 12, v36
    v_lshl_add_u32 v36, v37, 4, v36
    s_lshl_b32 s31, s29, 9
    s_lshl_b32 s44, s28, 7
    s_add_u32 s44, s44, s31
    s_add_u32 s44, s44, 851968
    s_add_u32 s45, s44, 32768
    s_add_u32 s46, s44, 65536
    s_add_u32 s47, s44, 98304
    s_add_u32 s48, s44, 131072
    s_add_u32 s49, s44, 163840
    s_add_u32 s50, s44, 196608
    s_add_u32 s51, s44, 229376
    v_lshlrev_b32 v40, 16, v10
    v_and_b32 v41, 0xffff0000, v10
    v_lshlrev_b32 v42, 16, v11
    v_and_b32 v43, 0xffff0000, v11
    s_cmp_lg_u32 s11, 1
    s_cbranch_scc1 L_npd
    v_not_b32 v60, v13
    v_not_b32 v61, v13
    v_not_b32 v62, v13
    v_not_b32 v63, v13
    s_mov_b32 s64, -1
    s_mov_b32 s65, 0xff
    s_mov_b64 exec, s[64:65]
    buffer_store_dwordx4 v[60:63], v6, s[56:59], s40 offen
    s_mov_b64 exec, -1
L_npd:
    s_barrier
    s_mov_b64 exec, s[62:63]
    ds_read_b128 v[20:23], v48 offset:40960
    ds_read_b128 v[24:27], v48 offset:41472
    ds_read_b128 v[28:31], v48 offset:41984
    ds_read_b128 v[32:35], v48 offset:42496
    s_waitcnt lgkmcnt(0)
    v_mul_f32 v16, v20, v44
    v_fma_f32 v17, v21, v44, v49
    v_mul_f32 v18, v22, v44
    v_mul_f32 v19, v23, v44
    v_fmac_f32 v16, v24, v45
    v_fmac_f32 v17, v25, v45
    v_fmac_f32 v18, v26, v45
    v_fmac_f32 v19, v27, v45
    v_fmac_f32 v16, v28, v46
    v_fmac_f32 v17, v29, v46
    v_fmac_f32 v18, v30, v46
    v_fmac_f32 v19, v31, v46
    v_fmac_f32 v16, v32, v47
    v_fmac_f32 v17, v33, v47
    v_fmac_f32 v18, v34, v47
    v_fmac_f32 v19, v35, v47
    v_bfi_b32 v16, s61, v13, v16
    v_bfi_b32 v17, s61, v13, v17
    v_bfi_b32 v18, v51, v13, v18
    v_bfi_b32 v19, v51, v13, v19
    s_cmp_eq_u32 s11, 1
    s_cbranch_scc1 L_hs_l
    buffer_store_dwordx4 v[16:19], v6, s[56:59], s40 offen sc1
    s_branch L_hs_e
L_hs_l:
    buffer_store_dwordx4 v[16:19], v6, s[56:59], s40 offen
L_hs_e:
    s_mov_b64 exec, s[78:79]
    buffer_store_dwordx4 v[52:55], v39, s[56:59], s42 offen sc1
    s_barrier
    ds_read_b128 v[20:23], v6 offset:38912
    ds_read_b128 v[24:27], v6 offset:39424
    ds_read_b128 v[28:31], v6 offset:39936
    ds_read_b128 v[32:35], v6 offset:40448
    s_waitcnt lgkmcnt(0)
    v_add_f32 v20, v20, v24
    v_add_f32 v28, v28, v32
    v_add_f32 v21, v21, v25
    v_add_f32 v29, v29, v33
    v_add_f32 v22, v22, v26
    v_add_f32 v30, v30, v34
    v_add_f32 v23, v23, v27
    v_add_f32 v31, v31, v35
    v_add_f32 v60, v20, v28
    v_add_f32 v61, v21, v29
    v_add_f32 v62, v22, v30
    v_add_f32 v63, v23, v31
    v_bfi_b32 v60, s61, v13, v60
    v_bfi_b32 v61, s61, v13, v61
    v_bfi_b32 v62, s61, v13, v62
    v_bfi_b32 v63, s61, v13, v63
    buffer_store_dwordx4 v[60:63], v6, s[56:59], s41 offen sc1
    s_mov_b64 exec, -1
    s_cmp_ge_u32 s28, 4
    s_cbranch_scc1 L_exit
    s_mov_b32 s77, 1048576
    s_and_b32 s74, s30, 0xff
L_pf:
    buffer_load_dwordx4 v[144:147], v36, s[56:59], s48 offen sc1
    buffer_load_dwordx4 v[148:151], v36, s[56:59], s49 offen sc1
    buffer_load_dwordx4 v[152:155], v36, s[56:59], s50 offen sc1
    buffer_load_dwordx4 v[156:159], v36, s[56:59], s51 offen sc1
    s_waitcnt vmcnt(0)
    v_xor_b32 v144, s74, v144
    v_xor_b32 v145, s74, v145
    v_xor_b32 v146, s74, v146
    v_xor_b32 v147, s74, v147
    v_xor_b32 v148, s74, v148
    v_xor_b32 v149, s74, v149
    v_xor_b32 v150, s74, v150
    v_xor_b32 v151, s74, v151
    v_xor_b32 v152, s74, v152
    v_xor_b32 v153, s74, v153
    v_xor_b32 v154, s74, v154
    v_xor_b32 v155, s74, v155
    v_xor_b32 v156, s74, v156
    v_xor_b32 v157, s74, v157
    v_xor_b32 v158, s74, v158
    v_xor_b32 v159, s74, v159
    v_or_b32 v250, v144, v145
    v_or3_b32 v250, v250, v146, v147
    v_or3_b32 v250, v250, v148, v149
    v_or3_b32 v250, v250, v150, v151
    v_or3_b32 v250, v250, v152, v153
    v_or3_b32 v250, v250, v154, v155
    v_or3_b32 v250, v250, v156, v157
    v_or3_b32 v250, v250, v158, v159
    v_and_b32 v250, 0xff, v250
    v_cmp_ne_u32 vcc, 0, v250
    s_nop 3
    s_cmp_eq_u64 vcc, 0
    s_cbranch_scc1 L_pf_ok
    s_sub_u32 s77, s77, 1
    s_cmp_eq_u32 s77, 0
    s_cbranch_scc1 L_pf_ok
    s_sleep 1
    s_branch L_pf
L_pf_ok:
    s_mov_b64 exec, -1
    v_add_f32 v144, v144, v148
    v_add_f32 v152, v152, v156
    v_add_f32 v145, v145, v149
    v_add_f32 v153, v153, v157
    v_add_f32 v146, v146, v150
    v_add_f32 v154, v154, v158
    v_add_f32 v147, v147, v151
    v_add_f32 v155, v155, v159
    v_add_f32 v144, v144, v152
    v_add_f32 v145, v145, v153
    v_add_f32 v146, v146, v154
    v_add_f32 v147, v147, v155
    v_add_f32_dpp v144, v144, v144 row_ror:8 row_mask:0xf bank_mask:0xf
    v_add_f32_dpp v145, v145, v145 row_ror:8 row_mask:0xf bank_mask:0xf
    v_add_f32_dpp v146, v146, v146 row_ror:8 row_mask:0xf bank_mask:0xf
    v_add_f32_dpp v147, v147, v147 row_ror:8 row_mask:0xf bank_mask:0xf
    v_mov_b32 v148, v144
    v_mov_b32 v149, v145
    v_mov_b32 v150, v146
    v_mov_b32 v151, v147
    v_permlane16_swap_b32 v144, v148
    v_permlane16_swap_b32 v145, v149
    v_permlane16_swap_b32 v146, v150
    v_permlane16_swap_b32 v147, v151
    v_add_f32 v144, v144, v148
    v_add_f32 v145, v145, v149
    v_add_f32 v146, v146, v150
    v_add_f32 v147, v147, v151
    v_mov_b32 v148, v144
    v_mov_b32 v149, v145
    v_mov_b32 v150, v146
    v_mov_b32 v151, v147
    v_permlane32_swap_b32 v144, v148
    v_permlane32_swap_b32 v145, v149
    v_permlane32_swap_b32 v146, v150
    v_permlane32_swap_b32 v147, v151
    v_add_f32 v144, v144, v148
    v_add_f32 v145, v145, v149
    v_add_f32 v146, v146, v150
    v_add_f32 v147, v147, v151
    v_cvt_pk_bf16_f32 v144, v144, v144
    v_and_b32 v144, 0xffff0000, v144
    v_cvt_pk_bf16_f32 v145, v145, v145
    v_and_b32 v145, 0xffff0000, v145
    v_cvt_pk_bf16_f32 v146, v146, v146
    v_and_b32 v146, 0xffff0000, v146
    v_cvt_pk_bf16_f32 v147, v147, v147
    v_and_b32 v147, 0xffff0000, v147
    s_nop 2
    s_mov_b32 s77, 1048576
    s_and_b32 s74, s30, 0xff
L_p2:
    buffer_load_dwordx4 v[128:131], v36, s[56:59], s44 offen sc1
    buffer_load_dwordx4 v[132:135], v36, s[56:59], s45 offen sc1
    buffer_load_dwordx4 v[136:139], v36, s[56:59], s46 offen sc1
    buffer_load_dwordx4 v[140:143], v36, s[56:59], s47 offen sc1
    s_waitcnt vmcnt(0)
    v_xor_b32 v128, s74, v128
    v_xor_b32 v129, s74, v129
    v_xor_b32 v130, s74, v130
    v_xor_b32 v131, s74, v131
    v_xor_b32 v132, s74, v132
    v_xor_b32 v133, s74, v133
    v_xor_b32 v134, s74, v134
    v_xor_b32 v135, s74, v135
    v_xor_b32 v136, s74, v136
    v_xor_b32 v137, s74, v137
    v_xor_b32 v138, s74, v138
    v_xor_b32 v139, s74, v139
    v_xor_b32 v140, s74, v140
    v_xor_b32 v141, s74, v141
    v_xor_b32 v142, s74, v142
    v_xor_b32 v143, s74, v143
    v_or_b32 v250, v128, v129
    v_or3_b32 v250, v250, v130, v131
    v_or3_b32 v250, v250, v132, v133
    v_or3_b32 v250, v250, v134, v135
    v_or3_b32 v250, v250, v136, v137
    v_or3_b32 v250, v250, v138, v139
    v_or3_b32 v250, v250, v140, v141
    v_or3_b32 v250, v250, v142, v143
    v_and_b32 v250, 0xff, v250
    v_cmp_ne_u32 vcc, 0, v250
    s_nop 3
    s_cmp_eq_u64 vcc, 0
    s_cbranch_scc1 L_p2_ok
    s_sub_u32 s77, s77, 1
    s_cmp_eq_u32 s77, 0
    s_cbranch_scc1 L_p2_ok
    s_sleep 1
    s_branch L_p2
L_p2_ok:
    s_mov_b64 exec, -1
    v_add_f32 v128, v128, v132
    v_add_f32 v136, v136, v140
    v_add_f32 v129, v129, v133
    v_add_f32 v137, v137, v141
    v_add_f32 v130, v130, v134
    v_add_f32 v138, v138, v142
    v_add_f32 v131, v131, v135
    v_add_f32 v139, v139, v143
    v_add_f32 v128, v128, v136
    v_add_f32 v129, v129, v137
    v_add_f32 v130, v130, v138
    v_add_f32 v131, v131, v139
    v_add_f32_dpp v128, v128, v128 row_ror:8 row_mask:0xf bank_mask:0xf
    v_add_f32_dpp v129, v129, v129 row_ror:8 row_mask:0xf bank_mask:0xf
    v_add_f32_dpp v130, v130, v130 row_ror:8 row_mask:0xf bank_mask:0xf
    v_add_f32_dpp v131, v131, v131 row_ror:8 row_mask:0xf bank_mask:0xf
    v_mov_b32 v132, v128
    v_mov_b32 v133, v129
    v_mov_b32 v134, v130
    v_mov_b32 v135, v131
    v_permlane16_swap_b32 v128, v132
    v_permlane16_swap_b32 v129, v133
    v_permlane16_swap_b32 v130, v134
    v_permlane16_swap_b32 v131, v135
    v_add_f32 v128, v128, v132
    v_add_f32 v129, v129, v133
    v_add_f32 v130, v130, v134
    v_add_f32 v131, v131, v135
    v_mov_b32 v132, v128
    v_mov_b32 v133, v129
    v_mov_b32 v134, v130
    v_mov_b32 v135, v131
    v_permlane32_swap_b32 v128, v132
    v_permlane32_swap_b32 v129, v133
    v_permlane32_swap_b32 v130, v134
    v_permlane32_swap_b32 v131, v135
    v_add_f32 v128, v128, v132
    v_add_f32 v129, v129, v133
    v_add_f32 v130, v130, v134
    v_add_f32 v131, v131, v135
    v_cvt_pk_bf16_f32 v128, v128, v128
    v_and_b32 v128, 0xffff0000, v128
    v_cvt_pk_bf16_f32 v129, v129, v129
    v_and_b32 v129, 0xffff0000, v129
    v_cvt_pk_bf16_f32 v130, v130, v130
    v_and_b32 v130, 0xffff0000, v130
    v_cvt_pk_bf16_f32 v131, v131, v131
    v_and_b32 v131, 0xffff0000, v131
    v_add_f32 v128, v128, v40
    v_add_f32 v129, v129, v41
    v_add_f32 v130, v130, v42
    v_add_f32 v131, v131, v43
    v_cvt_pk_bf16_f32 v128, v128, v128
    v_and_b32 v128, 0xffff0000, v128
    v_cvt_pk_bf16_f32 v129, v129, v129
    v_and_b32 v129, 0xffff0000, v129
    v_cvt_pk_bf16_f32 v130, v130, v130
    v_and_b32 v130, 0xffff0000, v130
    v_cvt_pk_bf16_f32 v131, v131, v131
    v_and_b32 v131, 0xffff0000, v131
    v_add_f32 v128, v128, v144
    v_add_f32 v129, v129, v145
    v_add_f32 v130, v130, v146
    v_add_f32 v131, v131, v147
    v_cvt_pk_bf16_f32 v20, v128, v129
    v_cvt_pk_bf16_f32 v21, v130, v131
    s_mov_b64 exec, 0xff
    buffer_store_dwordx2 v[20:21], v38, s[68:71], s75 offen
    s_mov_b64 exec, 1
    s_cmp_lg_u32 s2, 0
    s_cbranch_scc1 L_noep
    buffer_store_dword v13, v8, s[56:59], 0 offen
L_noep:
L_exit:
    s_endpgm
.fill (41984 - (. - parallel_sum__mha_block_cached__glu_gated_geglu__decode_kernel)) / 4, 4, 0xbf810000
.section .rodata,"a"
.p2align 6
.amdhsa_kernel parallel_sum__mha_block_cached__glu_gated_geglu__decode_kernel
  .amdhsa_next_free_vgpr 256
  .amdhsa_next_free_sgpr 102
  .amdhsa_accum_offset 256
  .amdhsa_group_segment_fixed_size 0
  .amdhsa_kernarg_size 96
  .amdhsa_user_sgpr_count 2
  .amdhsa_user_sgpr_kernarg_segment_ptr 1
  .amdhsa_system_sgpr_workgroup_id_x 1
  .amdhsa_float_denorm_mode_32 3
.end_amdhsa_kernel
```
